```python
import torch

def _softmax(x, axis=-1):
    return torch.softmax(x, dim=axis)
def _gelu(x):
    return torch.nn.functional.gelu(x, approximate="tanh")
def _silu(x):
    return torch.nn.functional.silu(x)
def _sigmoid(x):
    return torch.sigmoid(x)
def _layernorm(x, axis=-1, eps=1e-5):
    m = x.mean(dim=axis, keepdim=True)
    v = x.var(dim=axis, keepdim=True, unbiased=False)
    return (x - m) / torch.sqrt(v + eps)
def _scatter_add(tgt, idx, src, axis=0):
    return tgt.clone().index_add_(axis, idx, src)
def _segment_sum(src, seg, n):
    out = torch.zeros((n,) + src.shape[1:], dtype=src.dtype)
    return out.index_add_(0, seg, src)
def _pad(x, pw):
    flat = tuple(v for pair in reversed(pw) for v in pair)
    return torch.nn.functional.pad(x, flat)

kernel_name = 'sequential_preLN__ssm_conv_s4d__mixer_channel_mlp__prompt'

def setup_inputs():

    _w = (lambda a: (lambda t: t.to(torch.bfloat16) if t.is_floating_point() else t)(torch.as_tensor(a)))
    def _A_setup():
        Bsz, L, D, N = 1, 2048, 512, 128
        return {
            "u": _w((lambda *s: torch.randn(*s, dtype=torch.bfloat16) * 0.05)(Bsz, L, D)),
            "log_A_real": _w((lambda *s: torch.randn(*s, dtype=torch.bfloat16) * 3.2)(D, N) * 0.5),
            "A_imag": _w((lambda *s: torch.randn(*s, dtype=torch.bfloat16) * 0.05)(D, N) * 3.14),
            "C_real": _w((lambda *s: torch.randn(*s, dtype=torch.bfloat16) * 0.1)(D, N) / N ** 0.5),
            "C_imag": _w((lambda *s: torch.randn(*s, dtype=torch.bfloat16) * 0.2)(D, N) / N ** 0.5),
            "log_dt": _w((lambda *s: torch.randn(*s, dtype=torch.bfloat16) * 0.05)(D) * 0.5 - 4.0),
            "D_skip": _w((lambda *s: torch.randn(*s, dtype=torch.bfloat16) * 0.05)(D)),
        }
    _A_in = _A_setup()

    def _B_setup():
        B, S, D, F = 1, 2048, 512, 1376
        return {
            "x": _w((lambda *s: torch.randn(*s, dtype=torch.bfloat16) * 0.05)(B, S, D)),
            "w1": _w((lambda *s: torch.randn(*s, dtype=torch.bfloat16) * 1.6)(D, F) * (D ** -0.5)),
            "b1": _w((lambda *s: torch.randn(*s, dtype=torch.bfloat16) * 0.8)(F)),
            "w2": _w((lambda *s: torch.randn(*s, dtype=torch.bfloat16) * 0.05)(F, D) * (F ** -0.5)),
            "b2": _w((lambda *s: torch.randn(*s, dtype=torch.bfloat16) * 0.05)(D)),
        }
    _B_in = _B_setup()

    return {
        "A_u": _A_in["u"],
        "A_log_A_real": _A_in["log_A_real"],
        "A_A_imag": _A_in["A_imag"],
        "A_C_real": _A_in["C_real"],
        "A_C_imag": _A_in["C_imag"],
        "A_log_dt": _A_in["log_dt"],
        "A_D_skip": _A_in["D_skip"],
        "B_x": _B_in["x"],
        "B_w1": _B_in["w1"],
        "B_b1": _B_in["b1"],
        "B_w2": _B_in["w2"],
        "B_b2": _B_in["b2"],
    }

def reference(A_u, A_log_A_real, A_A_imag, A_C_real, A_C_imag, A_log_dt, A_D_skip, B_x, B_w1, B_b1, B_w2, B_b2):
    def _A_ref(u, log_A_real, A_imag, C_real, C_imag, log_dt, D_skip):
        L = u.shape[1]
        dt = torch.exp(log_dt)
        A = -torch.exp(log_A_real) + 1j * A_imag
        C = (C_real + 1j * C_imag) * dt[:, None]
        pos = (lambda x, dt: x.to(dt))(torch.arange(L), log_dt.dtype)
        P = torch.exp((A * dt[:, None])[:, :, None] * pos[None, None, :])
        K = 2.0 * torch.einsum("dn,dnl->dl", C, P).real
        L2 = 2 * L
        u_t = (lambda x, *d: x.permute(*d))(u, 0, 2, 1)
        Kf = (lambda x, *a, **k: torch.fft.rfft(x.float(), *a, **k))(K, L2)
        Uf = (lambda x, *a, **k: torch.fft.rfft(x.float(), *a, **k))(u_t, L2)
        y = (lambda x, *a, **k: torch.fft.irfft(x, *a, **k).to(torch.bfloat16))(Uf * Kf[None, :, :], L2)[:, :, :L]
        y = (lambda x, *d: x.permute(*d))(y, 0, 2, 1)
        return y + u * D_skip[None, None, :]

    def _B_ref(x, w1, b1, w2, b2):
        y = _layernorm(x, axis=-1)
        h = _gelu(torch.einsum("bsd,df->bsf", y, w1) + b1)
        return torch.einsum("bsf,fd->bsd", h, w2) + b2

    x = A_u
    h = x + _A_ref(_layernorm(x, axis=-1), A_log_A_real, A_A_imag, A_C_real, A_C_imag, A_log_dt, A_D_skip)
    h2 = h + _B_ref(_layernorm(h, axis=-1), B_w1, B_b1, B_w2, B_b2)
    return h2
```

```asm
; @launch kernel=ka_kernel grid=(256,1,1) block=(512,1,1) lds=128256
; @launch kernel=k3_kernel grid=(256,1,1) block=(512,1,1) lds=8320
; @launch kernel=k4_kernel grid=(240,1,1) block=(256,1,1) lds=143360
; @launch kernel=k5_kernel grid=(256,1,1) block=(256,1,1) lds=65536
.amdgcn_target "amdgcn-amd-amdhsa--gfx950"
.text
.globl ka_kernel
.p2align 8
.type ka_kernel,@function
ka_kernel:
    s_cmp_ge_u32 s2, 256
    s_cbranch_scc1 KA_END
    s_load_dwordx4 s[4:7], s[0:1], 8
    s_load_dwordx4 s[8:11], s[0:1], 24
    s_load_dwordx4 s[12:15], s[0:1], 40
    s_load_dwordx4 s[60:63], s[0:1], 104
    s_load_dwordx2 s[64:65], s[0:1], 0
    s_load_dwordx2 s[92:93], s[0:1], 64
    s_load_dwordx2 s[94:95], s[0:1], 80
    v_and_b32 v224, 255, v0
    v_and_b32 v225, 63, v0
    v_lshrrev_b32 v1, 6, v0
    s_nop 0
    v_readfirstlane_b32 s18, v1
    s_lshr_b32 s19, s18, 2
    s_and_b32 s96, s18, 3
    s_lshl_b32 s20, s2, 1
    s_add_u32 s20, s20, s19
    s_mul_i32 s21, s19, 64128
    v_mov_b32 v232, s21
    s_waitcnt lgkmcnt(0)
    s_mov_b32 s16, s62
    s_mov_b32 s17, s63
    s_mov_b32 s84, s64
    s_and_b32 s85, s65, 0xffff
    s_mov_b32 s86, 0x200000
    s_mov_b32 s87, 0x20000
    s_mov_b32 s88, s60
    s_and_b32 s89, s61, 0xffff
    s_mov_b32 s90, 0x100
    s_mov_b32 s91, 0x20000
    s_lshl_b32 s22, s2, 13
    v_lshlrev_b32 v1, 4, v0
    v_add_u32 v1, s22, v1
    buffer_load_dwordx4 v[112:115], v1, s[84:87], 0 offen
    s_mov_b32 s24, s4
    s_and_b32 s25, s5, 0xffff
    s_mov_b32 s26, 0x20000
    s_mov_b32 s27, 0x20000
    s_mov_b32 s28, s6
    s_and_b32 s29, s7, 0xffff
    s_mov_b32 s30, 0x20000
    s_mov_b32 s31, 0x20000
    s_mov_b32 s32, s8
    s_and_b32 s33, s9, 0xffff
    s_mov_b32 s34, 0x20000
    s_mov_b32 s35, 0x20000
    s_mov_b32 s36, s10
    s_and_b32 s37, s11, 0xffff
    s_mov_b32 s38, 0x20000
    s_mov_b32 s39, 0x20000
    s_mov_b32 s40, s12
    s_and_b32 s41, s13, 0xffff
    s_mov_b32 s42, 0x400
    s_mov_b32 s43, 0x20000
    s_mov_b32 s44, s14
    s_and_b32 s45, s15, 0xffff
    s_mov_b32 s46, 0x400
    s_mov_b32 s47, 0x20000
    s_mov_b32 s48, s16
    s_and_b32 s49, s17, 0xffff
    s_mov_b32 s50, 0x200000
    s_mov_b32 s51, 0x20000
    s_add_u32 s52, s16, 0x200000
    s_addc_u32 s53, s17, 0
    s_and_b32 s53, s53, 0xffff
    s_mov_b32 s54, 0x200000
    s_mov_b32 s55, 0x20000
    s_add_u32 s56, s16, 0x800000
    s_addc_u32 s57, s17, 0
    s_and_b32 s57, s57, 0xffff
    s_mov_b32 s58, 0x400000
    s_mov_b32 s59, 0x20000
    s_lshl_b32 s22, s20, 8
    v_and_b32 v1, 127, v224
    v_lshl_add_u32 v1, v1, 1, s22
    buffer_load_ushort v4, v1, s[24:27], 0 offen
    buffer_load_ushort v5, v1, s[28:31], 0 offen
    buffer_load_ushort v6, v1, s[32:35], 0 offen
    buffer_load_ushort v7, v1, s[36:39], 0 offen
    s_lshl_b32 s22, s20, 1
    v_mov_b32 v2, s22
    buffer_load_ushort v8, v2, s[40:43], 0 offen
    buffer_load_ushort v231, v2, s[44:47], 0 offen
    s_add_u32 s22, s20, 0
    s_cmp_lt_u32 s22, 352
    s_cselect_b32 s4, s92, s94
    s_cselect_b32 s5, s93, s95
    s_mov_b32 s26, 512
    s_cselect_b32 s26, 1376, s26
    s_lshl_b32 s27, s26, 1
    s_cmp_lt_u32 s22, 352
    s_cselect_b32 s28, 16, 43
    s_cselect_b32 s29, 0, 2097152
    s_and_b32 s5, s5, 0xffff
    s_mov_b32 s6, 1409024
    s_mov_b32 s7, 0x20000
    s_and_b32 s23, s22, 15
    s_lshr_b32 s97, s22, 4
    s_sub_u32 s98, s22, 352
    s_lshr_b32 s99, s98, 3
    s_and_b32 s98, s98, 7
    s_cselect_b32 s24, s23, s99
    s_cmp_lt_u32 s22, 352
    s_cselect_b32 s24, s23, s99
    s_cselect_b32 s25, s97, s98
    s_lshl_b32 s24, s24, 5
    s_lshl_b32 s25, s25, 6
    s_add_u32 s22, s20, 512
    s_cmp_lt_u32 s22, 352
    s_cselect_b32 s8, s92, s94
    s_cselect_b32 s9, s93, s95
    s_mov_b32 s32, 512
    s_cselect_b32 s32, 1376, s32
    s_lshl_b32 s33, s32, 1
    s_cmp_lt_u32 s22, 352
    s_cselect_b32 s34, 16, 43
    s_cselect_b32 s35, 0, 2097152
    s_and_b32 s9, s9, 0xffff
    s_mov_b32 s10, 1409024
    s_mov_b32 s11, 0x20000
    s_and_b32 s23, s22, 15
    s_lshr_b32 s97, s22, 4
    s_sub_u32 s98, s22, 352
    s_lshr_b32 s99, s98, 3
    s_and_b32 s98, s98, 7
    s_cselect_b32 s30, s23, s99
    s_cmp_lt_u32 s22, 352
    s_cselect_b32 s30, s23, s99
    s_cselect_b32 s31, s97, s98
    s_lshl_b32 s30, s30, 5
    s_lshl_b32 s31, s31, 6
    v_lshrrev_b32 v9, 3, v224
    v_and_b32 v10, 7, v224
    v_lshlrev_b32 v11, 3, v10
    v_add_u32 v11, s25, v11
    v_add_u32 v12, s24, v9
    v_mul_lo_u32 v12, v12, s27
    v_lshl_add_u32 v12, v11, 1, v12
    v_cmp_gt_u32 vcc, s26, v11
    v_mov_b32 v13, 0x7ffffff0
    s_nop 0
    v_cndmask_b32 v12, v13, v12, vcc
    buffer_load_dwordx4 v[236:239], v12, s[4:7], 0 offen
    v_lshlrev_b32 v11, 3, v10
    v_add_u32 v11, s31, v11
    v_add_u32 v12, s30, v9
    v_mul_lo_u32 v12, v12, s33
    v_lshl_add_u32 v12, v11, 1, v12
    v_cmp_gt_u32 vcc, s32, v11
    v_mov_b32 v13, 0x7ffffff0
    s_nop 0
    v_cndmask_b32 v12, v13, v12, vcc
    s_cmp_ge_u32 s20, 184
    s_cselect_b32 s10, 0, s10
    buffer_load_dwordx4 v[240:243], v12, s[8:11], 0 offen
    v_lshlrev_b32 v9, 3, v224
    v_sub_u32 v9, 2047, v9
    v_add_u32 v15, 19584, v232
    v_subrev_u32 v10, 0, v9
    v_cvt_f32_u32 v10, v10
    v_cvt_pk_bf16_f32 v10, v10, v10
    v_and_b32 v10, 0xffff0000, v10
    v_cvt_u32_f32 v11, v10
    v_bfe_u32 v10, v10, 23, 8
    v_subrev_u32 v10, 134, v10
    v_med3_i32 v10, v10, 0, 3
    v_lshrrev_b32 v12, 7, v11
    v_and_b32 v13, 7, v11
    v_bfe_u32 v11, v11, 3, 4
    v_sub_u32 v14, 3, v10
    v_lshlrev_b32 v12, v14, v12
    v_lshrrev_b32 v13, v10, v13
    v_lshl_add_u32 v12, v10, 3, v12
    v_add_u32 v12, v12, v13
    v_lshl_add_u32 v12, v12, 4, v11
    v_lshl_add_u32 v16, v12, 2, v15
    v_subrev_u32 v10, 1, v9
    v_cvt_f32_u32 v10, v10
    v_cvt_pk_bf16_f32 v10, v10, v10
    v_and_b32 v10, 0xffff0000, v10
    v_cvt_u32_f32 v11, v10
    v_bfe_u32 v10, v10, 23, 8
    v_subrev_u32 v10, 134, v10
    v_med3_i32 v10, v10, 0, 3
    v_lshrrev_b32 v12, 7, v11
    v_and_b32 v13, 7, v11
    v_bfe_u32 v11, v11, 3, 4
    v_sub_u32 v14, 3, v10
    v_lshlrev_b32 v12, v14, v12
    v_lshrrev_b32 v13, v10, v13
    v_lshl_add_u32 v12, v10, 3, v12
    v_add_u32 v12, v12, v13
    v_lshl_add_u32 v12, v12, 4, v11
    v_lshl_add_u32 v17, v12, 2, v15
    v_subrev_u32 v10, 2, v9
    v_cvt_f32_u32 v10, v10
    v_cvt_pk_bf16_f32 v10, v10, v10
    v_and_b32 v10, 0xffff0000, v10
    v_cvt_u32_f32 v11, v10
    v_bfe_u32 v10, v10, 23, 8
    v_subrev_u32 v10, 134, v10
    v_med3_i32 v10, v10, 0, 3
    v_lshrrev_b32 v12, 7, v11
    v_and_b32 v13, 7, v11
    v_bfe_u32 v11, v11, 3, 4
    v_sub_u32 v14, 3, v10
    v_lshlrev_b32 v12, v14, v12
    v_lshrrev_b32 v13, v10, v13
    v_lshl_add_u32 v12, v10, 3, v12
    v_add_u32 v12, v12, v13
    v_lshl_add_u32 v12, v12, 4, v11
    v_lshl_add_u32 v18, v12, 2, v15
    v_subrev_u32 v10, 3, v9
    v_cvt_f32_u32 v10, v10
    v_cvt_pk_bf16_f32 v10, v10, v10
    v_and_b32 v10, 0xffff0000, v10
    v_cvt_u32_f32 v11, v10
    v_bfe_u32 v10, v10, 23, 8
    v_subrev_u32 v10, 134, v10
    v_med3_i32 v10, v10, 0, 3
    v_lshrrev_b32 v12, 7, v11
    v_and_b32 v13, 7, v11
    v_bfe_u32 v11, v11, 3, 4
    v_sub_u32 v14, 3, v10
    v_lshlrev_b32 v12, v14, v12
    v_lshrrev_b32 v13, v10, v13
    v_lshl_add_u32 v12, v10, 3, v12
    v_add_u32 v12, v12, v13
    v_lshl_add_u32 v12, v12, 4, v11
    v_lshl_add_u32 v19, v12, 2, v15
    v_subrev_u32 v10, 4, v9
    v_cvt_f32_u32 v10, v10
    v_cvt_pk_bf16_f32 v10, v10, v10
    v_and_b32 v10, 0xffff0000, v10
    v_cvt_u32_f32 v11, v10
    v_bfe_u32 v10, v10, 23, 8
    v_subrev_u32 v10, 134, v10
    v_med3_i32 v10, v10, 0, 3
    v_lshrrev_b32 v12, 7, v11
    v_and_b32 v13, 7, v11
    v_bfe_u32 v11, v11, 3, 4
    v_sub_u32 v14, 3, v10
    v_lshlrev_b32 v12, v14, v12
    v_lshrrev_b32 v13, v10, v13
    v_lshl_add_u32 v12, v10, 3, v12
    v_add_u32 v12, v12, v13
    v_lshl_add_u32 v12, v12, 4, v11
    v_lshl_add_u32 v20, v12, 2, v15
    v_subrev_u32 v10, 5, v9
    v_cvt_f32_u32 v10, v10
    v_cvt_pk_bf16_f32 v10, v10, v10
    v_and_b32 v10, 0xffff0000, v10
    v_cvt_u32_f32 v11, v10
    v_bfe_u32 v10, v10, 23, 8
    v_subrev_u32 v10, 134, v10
    v_med3_i32 v10, v10, 0, 3
    v_lshrrev_b32 v12, 7, v11
    v_and_b32 v13, 7, v11
    v_bfe_u32 v11, v11, 3, 4
    v_sub_u32 v14, 3, v10
    v_lshlrev_b32 v12, v14, v12
    v_lshrrev_b32 v13, v10, v13
    v_lshl_add_u32 v12, v10, 3, v12
    v_add_u32 v12, v12, v13
    v_lshl_add_u32 v12, v12, 4, v11
    v_lshl_add_u32 v21, v12, 2, v15
    v_subrev_u32 v10, 6, v9
    v_cvt_f32_u32 v10, v10
    v_cvt_pk_bf16_f32 v10, v10, v10
    v_and_b32 v10, 0xffff0000, v10
    v_cvt_u32_f32 v11, v10
    v_bfe_u32 v10, v10, 23, 8
    v_subrev_u32 v10, 134, v10
    v_med3_i32 v10, v10, 0, 3
    v_lshrrev_b32 v12, 7, v11
    v_and_b32 v13, 7, v11
    v_bfe_u32 v11, v11, 3, 4
    v_sub_u32 v14, 3, v10
    v_lshlrev_b32 v12, v14, v12
    v_lshrrev_b32 v13, v10, v13
    v_lshl_add_u32 v12, v10, 3, v12
    v_add_u32 v12, v12, v13
    v_lshl_add_u32 v12, v12, 4, v11
    v_lshl_add_u32 v22, v12, 2, v15
    v_subrev_u32 v10, 7, v9
    v_cvt_f32_u32 v10, v10
    v_cvt_pk_bf16_f32 v10, v10, v10
    v_and_b32 v10, 0xffff0000, v10
    v_cvt_u32_f32 v11, v10
    v_bfe_u32 v10, v10, 23, 8
    v_subrev_u32 v10, 134, v10
    v_med3_i32 v10, v10, 0, 3
    v_lshrrev_b32 v12, 7, v11
    v_and_b32 v13, 7, v11
    v_bfe_u32 v11, v11, 3, 4
    v_sub_u32 v14, 3, v10
    v_lshlrev_b32 v12, v14, v12
    v_lshrrev_b32 v13, v10, v13
    v_lshl_add_u32 v12, v10, 3, v12
    v_add_u32 v12, v12, v13
    v_lshl_add_u32 v12, v12, 4, v11
    v_lshl_add_u32 v23, v12, 2, v15
    v_and_b32 v233, 15, v225
    v_lshrrev_b32 v234, 4, v225
    v_cmp_le_u32 vcc, 8, v233
    v_add_u32 v9, 120, v233
    s_nop 0
    v_cndmask_b32 v44, v233, v9, vcc
    v_cvt_f32_u32 v44, v44
    v_lshrrev_b32 v9, 2, v233
    v_lshlrev_b32 v9, 7, v9
    v_and_b32 v10, 3, v233
    v_lshl_add_u32 v9, v10, 1, v9
    v_add_u32 v9, 256, v9
    v_subrev_u32 v10, 8, v233
    v_lshrrev_b32 v10, 1, v10
    v_lshlrev_b32 v10, 7, v10
    v_and_b32 v11, 1, v233
    v_lshl_add_u32 v10, v11, 2, v10
    v_add_u32 v10, 512, v10
    v_cndmask_b32 v45, v9, v10, vcc
    v_cvt_f32_u32 v45, v45
    v_lshlrev_b32 v9, 7, v233
    v_add_u32 v9, 1024, v9
    v_min_u32 v9, 2048, v9
    v_cvt_f32_u32 v46, v9
    v_lshlrev_b32 v9, 3, v233
    v_cvt_f32_u32 v47, v9
    s_lshl_b32 s22, s96, 9
    s_add_u32 s22, s22, 17536
    v_lshl_add_u32 v48, v234, 6, v232
    v_add_u32 v48, s22, v48
    s_waitcnt vmcnt(8)
    v_lshlrev_b32 v2, 4, v225
    s_lshl_b32 s22, s18, 1
    v_add_u32 v2, s22, v2
    v_lshlrev_b32 v120, 16, v112
    v_and_b32 v121, 0xffff0000, v112
    v_lshlrev_b32 v122, 16, v113
    v_and_b32 v123, 0xffff0000, v113
    v_lshlrev_b32 v124, 16, v114
    v_and_b32 v125, 0xffff0000, v114
    v_lshlrev_b32 v126, 16, v115
    v_and_b32 v127, 0xffff0000, v115
    v_add_f32 v136, v120, v121
    v_add_f32 v137, v122, v123
    v_add_f32 v138, v124, v125
    v_add_f32 v139, v126, v127
    v_add_f32 v136, v136, v137
    v_add_f32 v138, v138, v139
    v_add_f32 v136, v136, v138
    s_nop 1
    v_add_f32_dpp v137, v136, v136 quad_perm:[1,0,3,2] row_mask:0xf bank_mask:0xf
    s_nop 1
    v_add_f32_dpp v137, v137, v137 quad_perm:[2,3,0,1] row_mask:0xf bank_mask:0xf
    s_nop 1
    v_add_f32_dpp v137, v137, v137 row_half_mirror row_mask:0xf bank_mask:0xf
    s_nop 1
    v_add_f32_dpp v137, v137, v137 row_mirror row_mask:0xf bank_mask:0xf
    s_nop 1
    v_add_f32_dpp v137, v137, v137 row_bcast:15 row_mask:0xa bank_mask:0xf
    s_nop 1
    v_add_f32_dpp v137, v137, v137 row_bcast:31 row_mask:0xc bank_mask:0xf
    s_nop 0
    v_readlane_b32 s66, v137, 63
    s_nop 1
    v_mov_b32 v140, s66
    v_mul_f32 v140, 0x3b000000, v140
    v_sub_f32 v143, v120, v140
    v_sub_f32 v144, v121, v140
    v_sub_f32 v145, v122, v140
    v_sub_f32 v146, v123, v140
    v_sub_f32 v147, v124, v140
    v_sub_f32 v148, v125, v140
    v_sub_f32 v149, v126, v140
    v_sub_f32 v150, v127, v140
    v_mul_f32 v136, v143, v143
    v_mul_f32 v137, v144, v144
    v_fmac_f32 v136, v145, v145
    v_fmac_f32 v137, v146, v146
    v_fmac_f32 v136, v147, v147
    v_fmac_f32 v137, v148, v148
    v_fmac_f32 v136, v149, v149
    v_fmac_f32 v137, v150, v150
    v_add_f32 v136, v136, v137
    s_nop 1
    v_add_f32_dpp v137, v136, v136 quad_perm:[1,0,3,2] row_mask:0xf bank_mask:0xf
    s_nop 1
    v_add_f32_dpp v137, v137, v137 quad_perm:[2,3,0,1] row_mask:0xf bank_mask:0xf
    s_nop 1
    v_add_f32_dpp v137, v137, v137 row_half_mirror row_mask:0xf bank_mask:0xf
    s_nop 1
    v_add_f32_dpp v137, v137, v137 row_mirror row_mask:0xf bank_mask:0xf
    s_nop 1
    v_add_f32_dpp v137, v137, v137 row_bcast:15 row_mask:0xa bank_mask:0xf
    s_nop 1
    v_add_f32_dpp v137, v137, v137 row_bcast:31 row_mask:0xc bank_mask:0xf
    s_nop 0
    v_readlane_b32 s67, v137, 63
    v_cvt_pk_bf16_f32 v141, v140, v140
    v_and_b32 v141, 0xffff0000, v141
    v_mov_b32 v136, s67
    v_mul_f32 v136, 0x3b000000, v136
    v_cvt_pk_bf16_f32 v136, v136, v136
    v_and_b32 v136, 0xffff0000, v136
    v_add_f32 v136, 0x3727c5ac, v136
    v_cvt_pk_bf16_f32 v136, v136, v136
    v_and_b32 v136, 0xffff0000, v136
    v_sqrt_f32 v136, v136
    s_nop 5
    v_cvt_pk_bf16_f32 v136, v136, v136
    v_and_b32 v136, 0xffff0000, v136
    v_rcp_f32 v142, v136
    v_sub_f32 v143, v120, v141
    v_sub_f32 v144, v121, v141
    v_sub_f32 v145, v122, v141
    v_sub_f32 v146, v123, v141
    v_sub_f32 v147, v124, v141
    v_sub_f32 v148, v125, v141
    v_sub_f32 v149, v126, v141
    v_sub_f32 v150, v127, v141
    v_cvt_pk_bf16_f32 v136, v143, v144
    v_cvt_pk_bf16_f32 v137, v145, v146
    v_cvt_pk_bf16_f32 v138, v147, v148
    v_cvt_pk_bf16_f32 v139, v149, v150
    v_lshlrev_b32 v143, 16, v136
    v_and_b32 v144, 0xffff0000, v136
    v_lshlrev_b32 v145, 16, v137
    v_and_b32 v146, 0xffff0000, v137
    v_lshlrev_b32 v147, 16, v138
    v_and_b32 v148, 0xffff0000, v138
    v_lshlrev_b32 v149, 16, v139
    v_and_b32 v150, 0xffff0000, v139
    v_mul_f32 v143, v143, v142
    v_mul_f32 v144, v144, v142
    v_mul_f32 v145, v145, v142
    v_mul_f32 v146, v146, v142
    v_mul_f32 v147, v147, v142
    v_mul_f32 v148, v148, v142
    v_mul_f32 v149, v149, v142
    v_mul_f32 v150, v150, v142
    v_cvt_pk_bf16_f32 v128, v143, v144
    v_cvt_pk_bf16_f32 v129, v145, v146
    v_cvt_pk_bf16_f32 v130, v147, v148
    v_cvt_pk_bf16_f32 v131, v149, v150
    ds_write_b16 v2, v128 offset:0
    ds_write_b16_d16_hi v2, v128 offset:1040
    ds_write_b16 v2, v129 offset:2080
    ds_write_b16_d16_hi v2, v129 offset:3120
    ds_write_b16 v2, v130 offset:4160
    ds_write_b16_d16_hi v2, v130 offset:5200
    ds_write_b16 v2, v131 offset:6240
    ds_write_b16_d16_hi v2, v131 offset:7280
    v_and_b32 v3, 7, v0
    v_mul_u32_u24 v3, 65, v3
    v_lshrrev_b32 v1, 3, v0
    v_add_lshl_u32 v3, v3, v1, 4
    s_lshl_b32 s22, s2, 13
    v_lshlrev_b32 v1, 4, v0
    v_add_u32 v1, s22, v1
    s_waitcnt lgkmcnt(0)
    s_barrier
    ds_read_b128 v[120:123], v3
    s_waitcnt lgkmcnt(0)
    buffer_store_dwordx4 v[120:123], v1, s[48:51], 0 offen sc1
    s_waitcnt vmcnt(3)
    v_lshlrev_b32 v4, 16, v4
    v_lshlrev_b32 v5, 16, v5
    v_lshlrev_b32 v6, 16, v6
    v_lshlrev_b32 v7, 16, v7
    v_lshlrev_b32 v8, 16, v8
    v_lshlrev_b32 v231, 16, v231
    v_mul_f32 v10, 0x3fb8aa3b, v8
    v_mov_b32 v15, 0x3fb8aa3b
    v_fma_f32 v15, v8, v15, -v10
    v_fmac_f32 v15, 0x32a57060, v8
    v_exp_f32 v9, v10
    v_mul_f32 v15, 0x3f317218, v15
    s_nop 4
    v_fmac_f32 v9, v9, v15
    v_cvt_pk_bf16_f32 v9, v9, v9
    v_and_b32 v9, 0xffff0000, v9
    v_mul_f32 v10, 0x3fb8aa3b, v4
    v_mov_b32 v15, 0x3fb8aa3b
    v_fma_f32 v15, v4, v15, -v10
    v_fmac_f32 v15, 0x32a57060, v4
    v_exp_f32 v128, v10
    v_mul_f32 v15, 0x3f317218, v15
    s_nop 4
    v_fmac_f32 v128, v128, v15
    v_cvt_pk_bf16_f32 v128, v128, v128
    v_and_b32 v128, 0xffff0000, v128
    v_mul_f32 v128, v128, v9
    v_mul_f32 v128, 0xbfb8aa3b, v128
    v_mul_f32 v129, v5, v9
    v_mul_f32 v129, 0.15915494, v129
    v_mul_f32 v130, v6, v9
    v_add_f32 v130, v130, v130
    v_mul_f32 v131, v7, v9
    v_add_f32 v131, v131, v131
    v_and_b32 v9, 127, v224
    v_lshl_add_u32 v9, v9, 4, v232
    ds_write_b128 v9, v[128:131] offset:17536
    v_mov_b32 v96, 0
    v_mov_b32 v97, 0
    v_mov_b32 v98, 0
    v_mov_b32 v99, 0
    v_mov_b32 v100, 0
    v_mov_b32 v101, 0
    v_mov_b32 v102, 0
    v_mov_b32 v103, 0
    v_mov_b32 v104, 0
    v_mov_b32 v105, 0
    v_mov_b32 v106, 0
    v_mov_b32 v107, 0
    s_waitcnt lgkmcnt(0)
    s_barrier
    ds_read_b128 v[128:131], v48 offset:0
    ds_read_b128 v[132:135], v48 offset:16
    ds_read_b128 v[136:139], v48 offset:32
    ds_read_b128 v[140:143], v48 offset:48
    s_waitcnt lgkmcnt(0)
    v_pk_mul_f32 v[144:145], v[128:129], v[46:47] op_sel:[0,1] op_sel_hi:[1,1]
    v_fract_f32 v145, v145
    v_pk_mul_f32 v[152:153], v[128:129], v[44:45] op_sel_hi:[1,0]
    v_fract_f32 v153, v153
    v_pk_mul_f32 v[160:161], v[128:129], v[44:45] op_sel:[0,1] op_sel_hi:[1,1]
    v_fract_f32 v161, v161
    v_pk_mul_f32 v[168:169], v[128:129], v[46:47] op_sel_hi:[1,0]
    v_fract_f32 v169, v169
    v_exp_f32 v144, v144
    v_cos_f32 v146, v145
    v_sin_f32 v147, v145
    v_exp_f32 v152, v152
    v_cos_f32 v154, v153
    v_sin_f32 v155, v153
    v_exp_f32 v160, v160
    v_cos_f32 v162, v161
    v_sin_f32 v163, v161
    v_exp_f32 v168, v168
    v_cos_f32 v170, v169
    v_sin_f32 v171, v169
    v_pk_mul_f32 v[176:177], v[132:133], v[46:47] op_sel:[0,1] op_sel_hi:[1,1]
    v_fract_f32 v177, v177
    v_pk_mul_f32 v[184:185], v[132:133], v[44:45] op_sel_hi:[1,0]
    v_fract_f32 v185, v185
    v_pk_mul_f32 v[192:193], v[132:133], v[44:45] op_sel:[0,1] op_sel_hi:[1,1]
    v_fract_f32 v193, v193
    v_pk_mul_f32 v[200:201], v[132:133], v[46:47] op_sel_hi:[1,0]
    v_fract_f32 v201, v201
    v_exp_f32 v176, v176
    v_cos_f32 v178, v177
    v_sin_f32 v179, v177
    v_exp_f32 v184, v184
    v_cos_f32 v186, v185
    v_sin_f32 v187, v185
    v_exp_f32 v192, v192
    v_cos_f32 v194, v193
    v_sin_f32 v195, v193
    v_exp_f32 v200, v200
    v_cos_f32 v202, v201
    v_sin_f32 v203, v201
    v_pk_mul_f32 v[148:149], v[146:147], v[144:145] op_sel_hi:[1,0]
    v_cvt_pk_bf16_f32 v60, v148, v149
    v_lshlrev_b32 v150, 16, v60
    v_and_b32 v151, 0xffff0000, v60
    v_pk_add_f32 v[148:149], v[148:149], v[150:151] neg_lo:[0,1] neg_hi:[0,1]
    v_cvt_pk_bf16_f32 v64, v148, v149
    v_pk_mul_f32 v[154:155], v[154:155], v[152:153] op_sel_hi:[1,0]
    v_pk_mul_f32 v[156:157], v[130:131], v[154:155] op_sel_hi:[1,0]
    v_pk_fma_f32 v[156:157], v[130:131], v[154:155], v[156:157] op_sel:[1,1,0] op_sel_hi:[0,1,1] neg_lo:[1,0,0] neg_hi:[1,0,1]
    v_cvt_pk_bf16_f32 v68, v156, v157
    v_lshlrev_b32 v158, 16, v68
    v_and_b32 v159, 0xffff0000, v68
    v_pk_add_f32 v[156:157], v[156:157], v[158:159] neg_lo:[0,1] neg_hi:[0,1]
    v_cvt_pk_bf16_f32 v72, v156, v157
    v_pk_mul_f32 v[162:163], v[162:163], v[160:161] op_sel_hi:[1,0]
    v_pk_mul_f32 v[164:165], v[130:131], v[162:163] op_sel_hi:[1,0]
    v_pk_fma_f32 v[164:165], v[130:131], v[162:163], v[164:165] op_sel:[1,1,0] op_sel_hi:[0,1,1] neg_lo:[1,0,0] neg_hi:[1,0,1]
    v_cvt_pk_bf16_f32 v76, v164, v165
    v_lshlrev_b32 v166, 16, v76
    v_and_b32 v167, 0xffff0000, v76
    v_pk_add_f32 v[164:165], v[164:165], v[166:167] neg_lo:[0,1] neg_hi:[0,1]
    v_cvt_pk_bf16_f32 v80, v164, v165
    v_pk_mul_f32 v[170:171], v[170:171], v[168:169] op_sel_hi:[1,0]
    v_pk_mul_f32 v[172:173], v[130:131], v[170:171] op_sel_hi:[1,0]
    v_pk_fma_f32 v[172:173], v[130:131], v[170:171], v[172:173] op_sel:[1,1,0] op_sel_hi:[0,1,1] neg_lo:[1,0,0] neg_hi:[1,0,1]
    v_cvt_pk_bf16_f32 v84, v172, v173
    v_lshlrev_b32 v174, 16, v84
    v_and_b32 v175, 0xffff0000, v84
    v_pk_add_f32 v[172:173], v[172:173], v[174:175] neg_lo:[0,1] neg_hi:[0,1]
    v_cvt_pk_bf16_f32 v88, v172, v173
    v_pk_mul_f32 v[144:145], v[136:137], v[46:47] op_sel:[0,1] op_sel_hi:[1,1]
    v_fract_f32 v145, v145
    v_pk_mul_f32 v[152:153], v[136:137], v[44:45] op_sel_hi:[1,0]
    v_fract_f32 v153, v153
    v_pk_mul_f32 v[160:161], v[136:137], v[44:45] op_sel:[0,1] op_sel_hi:[1,1]
    v_fract_f32 v161, v161
    v_pk_mul_f32 v[168:169], v[136:137], v[46:47] op_sel_hi:[1,0]
    v_fract_f32 v169, v169
    v_exp_f32 v144, v144
    v_cos_f32 v146, v145
    v_sin_f32 v147, v145
    v_exp_f32 v152, v152
    v_cos_f32 v154, v153
    v_sin_f32 v155, v153
    v_exp_f32 v160, v160
    v_cos_f32 v162, v161
    v_sin_f32 v163, v161
    v_exp_f32 v168, v168
    v_cos_f32 v170, v169
    v_sin_f32 v171, v169
    v_pk_mul_f32 v[180:181], v[178:179], v[176:177] op_sel_hi:[1,0]
    v_cvt_pk_bf16_f32 v61, v180, v181
    v_lshlrev_b32 v182, 16, v61
    v_and_b32 v183, 0xffff0000, v61
    v_pk_add_f32 v[180:181], v[180:181], v[182:183] neg_lo:[0,1] neg_hi:[0,1]
    v_cvt_pk_bf16_f32 v65, v180, v181
    v_pk_mul_f32 v[186:187], v[186:187], v[184:185] op_sel_hi:[1,0]
    v_pk_mul_f32 v[188:189], v[134:135], v[186:187] op_sel_hi:[1,0]
    v_pk_fma_f32 v[188:189], v[134:135], v[186:187], v[188:189] op_sel:[1,1,0] op_sel_hi:[0,1,1] neg_lo:[1,0,0] neg_hi:[1,0,1]
    v_cvt_pk_bf16_f32 v69, v188, v189
    v_lshlrev_b32 v190, 16, v69
    v_and_b32 v191, 0xffff0000, v69
    s_waitcnt vmcnt(0)
    s_barrier
    s_and_b32 s22, s2, 63
    s_lshl_b32 s22, s22, 2
    v_mov_b32 v1, s22
    v_mov_b32 v2, 1
    v_cmp_eq_u32 vcc, 0, v0
    s_and_saveexec_b64 s[36:37], vcc
    s_cbranch_execz KA_ARR
    buffer_atomic_add v2, v1, s[88:91], 0 offen sc1
KA_ARR:
    s_mov_b64 exec, s[36:37]
    v_pk_add_f32 v[188:189], v[188:189], v[190:191] neg_lo:[0,1] neg_hi:[0,1]
    v_cvt_pk_bf16_f32 v73, v188, v189
    v_pk_mul_f32 v[194:195], v[194:195], v[192:193] op_sel_hi:[1,0]
    v_pk_mul_f32 v[196:197], v[134:135], v[194:195] op_sel_hi:[1,0]
    v_pk_fma_f32 v[196:197], v[134:135], v[194:195], v[196:197] op_sel:[1,1,0] op_sel_hi:[0,1,1] neg_lo:[1,0,0] neg_hi:[1,0,1]
    v_cvt_pk_bf16_f32 v77, v196, v197
    v_lshlrev_b32 v198, 16, v77
    v_and_b32 v199, 0xffff0000, v77
    v_pk_add_f32 v[196:197], v[196:197], v[198:199] neg_lo:[0,1] neg_hi:[0,1]
    v_cvt_pk_bf16_f32 v81, v196, v197
    v_pk_mul_f32 v[202:203], v[202:203], v[200:201] op_sel_hi:[1,0]
    v_pk_mul_f32 v[204:205], v[134:135], v[202:203] op_sel_hi:[1,0]
    v_pk_fma_f32 v[204:205], v[134:135], v[202:203], v[204:205] op_sel:[1,1,0] op_sel_hi:[0,1,1] neg_lo:[1,0,0] neg_hi:[1,0,1]
    v_cvt_pk_bf16_f32 v85, v204, v205
    v_lshlrev_b32 v206, 16, v85
    v_and_b32 v207, 0xffff0000, v85
    v_pk_add_f32 v[204:205], v[204:205], v[206:207] neg_lo:[0,1] neg_hi:[0,1]
    v_cvt_pk_bf16_f32 v89, v204, v205
    v_pk_mul_f32 v[176:177], v[140:141], v[46:47] op_sel:[0,1] op_sel_hi:[1,1]
    v_fract_f32 v177, v177
    v_pk_mul_f32 v[184:185], v[140:141], v[44:45] op_sel_hi:[1,0]
    v_fract_f32 v185, v185
    v_pk_mul_f32 v[192:193], v[140:141], v[44:45] op_sel:[0,1] op_sel_hi:[1,1]
    v_fract_f32 v193, v193
    v_pk_mul_f32 v[200:201], v[140:141], v[46:47] op_sel_hi:[1,0]
    v_fract_f32 v201, v201
    v_exp_f32 v176, v176
    v_cos_f32 v178, v177
    v_sin_f32 v179, v177
    v_exp_f32 v184, v184
    v_cos_f32 v186, v185
    v_sin_f32 v187, v185
    v_exp_f32 v192, v192
    v_cos_f32 v194, v193
    v_sin_f32 v195, v193
    v_exp_f32 v200, v200
    v_cos_f32 v202, v201
    v_sin_f32 v203, v201
    v_pk_mul_f32 v[148:149], v[146:147], v[144:145] op_sel_hi:[1,0]
    v_cvt_pk_bf16_f32 v62, v148, v149
    v_lshlrev_b32 v150, 16, v62
    v_and_b32 v151, 0xffff0000, v62
    v_pk_add_f32 v[148:149], v[148:149], v[150:151] neg_lo:[0,1] neg_hi:[0,1]
    v_cvt_pk_bf16_f32 v66, v148, v149
    v_pk_mul_f32 v[154:155], v[154:155], v[152:153] op_sel_hi:[1,0]
    v_pk_mul_f32 v[156:157], v[138:139], v[154:155] op_sel_hi:[1,0]
    v_pk_fma_f32 v[156:157], v[138:139], v[154:155], v[156:157] op_sel:[1,1,0] op_sel_hi:[0,1,1] neg_lo:[1,0,0] neg_hi:[1,0,1]
    v_cvt_pk_bf16_f32 v70, v156, v157
    v_lshlrev_b32 v158, 16, v70
    v_and_b32 v159, 0xffff0000, v70
    v_pk_add_f32 v[156:157], v[156:157], v[158:159] neg_lo:[0,1] neg_hi:[0,1]
    v_cvt_pk_bf16_f32 v74, v156, v157
    v_pk_mul_f32 v[162:163], v[162:163], v[160:161] op_sel_hi:[1,0]
    v_pk_mul_f32 v[164:165], v[138:139], v[162:163] op_sel_hi:[1,0]
    v_pk_fma_f32 v[164:165], v[138:139], v[162:163], v[164:165] op_sel:[1,1,0] op_sel_hi:[0,1,1] neg_lo:[1,0,0] neg_hi:[1,0,1]
    v_cvt_pk_bf16_f32 v78, v164, v165
    v_lshlrev_b32 v166, 16, v78
    v_and_b32 v167, 0xffff0000, v78
    v_pk_add_f32 v[164:165], v[164:165], v[166:167] neg_lo:[0,1] neg_hi:[0,1]
    v_cvt_pk_bf16_f32 v82, v164, v165
    v_pk_mul_f32 v[170:171], v[170:171], v[168:169] op_sel_hi:[1,0]
    v_pk_mul_f32 v[172:173], v[138:139], v[170:171] op_sel_hi:[1,0]
    v_pk_fma_f32 v[172:173], v[138:139], v[170:171], v[172:173] op_sel:[1,1,0] op_sel_hi:[0,1,1] neg_lo:[1,0,0] neg_hi:[1,0,1]
    v_cvt_pk_bf16_f32 v86, v172, v173
    v_lshlrev_b32 v174, 16, v86
    v_and_b32 v175, 0xffff0000, v86
    v_pk_add_f32 v[172:173], v[172:173], v[174:175] neg_lo:[0,1] neg_hi:[0,1]
    v_cvt_pk_bf16_f32 v90, v172, v173
    s_nop 15
    s_nop 7
    v_pk_mul_f32 v[180:181], v[178:179], v[176:177] op_sel_hi:[1,0]
    v_cvt_pk_bf16_f32 v63, v180, v181
    v_lshlrev_b32 v182, 16, v63
    v_and_b32 v183, 0xffff0000, v63
    v_pk_add_f32 v[180:181], v[180:181], v[182:183] neg_lo:[0,1] neg_hi:[0,1]
    v_cvt_pk_bf16_f32 v67, v180, v181
    v_pk_mul_f32 v[186:187], v[186:187], v[184:185] op_sel_hi:[1,0]
    v_pk_mul_f32 v[188:189], v[142:143], v[186:187] op_sel_hi:[1,0]
    v_pk_fma_f32 v[188:189], v[142:143], v[186:187], v[188:189] op_sel:[1,1,0] op_sel_hi:[0,1,1] neg_lo:[1,0,0] neg_hi:[1,0,1]
    v_cvt_pk_bf16_f32 v71, v188, v189
    v_lshlrev_b32 v190, 16, v71
    v_and_b32 v191, 0xffff0000, v71
    v_pk_add_f32 v[188:189], v[188:189], v[190:191] neg_lo:[0,1] neg_hi:[0,1]
    v_cvt_pk_bf16_f32 v75, v188, v189
    v_pk_mul_f32 v[194:195], v[194:195], v[192:193] op_sel_hi:[1,0]
    v_pk_mul_f32 v[196:197], v[142:143], v[194:195] op_sel_hi:[1,0]
    v_pk_fma_f32 v[196:197], v[142:143], v[194:195], v[196:197] op_sel:[1,1,0] op_sel_hi:[0,1,1] neg_lo:[1,0,0] neg_hi:[1,0,1]
    v_cvt_pk_bf16_f32 v79, v196, v197
    v_lshlrev_b32 v198, 16, v79
    v_and_b32 v199, 0xffff0000, v79
    v_pk_add_f32 v[196:197], v[196:197], v[198:199] neg_lo:[0,1] neg_hi:[0,1]
    v_cvt_pk_bf16_f32 v83, v196, v197
    v_pk_mul_f32 v[202:203], v[202:203], v[200:201] op_sel_hi:[1,0]
    v_pk_mul_f32 v[204:205], v[142:143], v[202:203] op_sel_hi:[1,0]
    v_pk_fma_f32 v[204:205], v[142:143], v[202:203], v[204:205] op_sel:[1,1,0] op_sel_hi:[0,1,1] neg_lo:[1,0,0] neg_hi:[1,0,1]
    v_cvt_pk_bf16_f32 v87, v204, v205
    v_lshlrev_b32 v206, 16, v87
    v_and_b32 v207, 0xffff0000, v87
    v_pk_add_f32 v[204:205], v[204:205], v[206:207] neg_lo:[0,1] neg_hi:[0,1]
    v_cvt_pk_bf16_f32 v91, v204, v205
    v_mfma_f32_16x16x32_bf16 v[96:99], v[68:71], v[60:63], v[96:99]
    v_mfma_f32_16x16x32_bf16 v[96:99], v[68:71], v[64:67], v[96:99]
    v_mfma_f32_16x16x32_bf16 v[96:99], v[72:75], v[60:63], v[96:99]
    v_mfma_f32_16x16x32_bf16 v[100:103], v[76:79], v[60:63], v[100:103]
    v_mfma_f32_16x16x32_bf16 v[100:103], v[76:79], v[64:67], v[100:103]
    v_mfma_f32_16x16x32_bf16 v[100:103], v[80:83], v[60:63], v[100:103]
    v_mfma_f32_16x16x32_bf16 v[104:107], v[84:87], v[60:63], v[104:107]
    v_mfma_f32_16x16x32_bf16 v[104:107], v[84:87], v[64:67], v[104:107]
    v_mfma_f32_16x16x32_bf16 v[104:107], v[88:91], v[60:63], v[104:107]
    s_nop 15
    s_nop 15
    ds_read_b128 v[128:131], v48 offset:256
    ds_read_b128 v[132:135], v48 offset:272
    ds_read_b128 v[136:139], v48 offset:288
    ds_read_b128 v[140:143], v48 offset:304
    s_waitcnt lgkmcnt(0)
    v_pk_mul_f32 v[144:145], v[128:129], v[46:47] op_sel:[0,1] op_sel_hi:[1,1]
    v_fract_f32 v145, v145
    v_pk_mul_f32 v[152:153], v[128:129], v[44:45] op_sel_hi:[1,0]
    v_fract_f32 v153, v153
    v_pk_mul_f32 v[160:161], v[128:129], v[44:45] op_sel:[0,1] op_sel_hi:[1,1]
    v_fract_f32 v161, v161
    v_pk_mul_f32 v[168:169], v[128:129], v[46:47] op_sel_hi:[1,0]
    v_fract_f32 v169, v169
    v_exp_f32 v144, v144
    v_cos_f32 v146, v145
    v_sin_f32 v147, v145
    v_exp_f32 v152, v152
    v_cos_f32 v154, v153
    v_sin_f32 v155, v153
    v_exp_f32 v160, v160
    v_cos_f32 v162, v161
    v_sin_f32 v163, v161
    v_exp_f32 v168, v168
    v_cos_f32 v170, v169
    v_sin_f32 v171, v169
    v_pk_mul_f32 v[176:177], v[132:133], v[46:47] op_sel:[0,1] op_sel_hi:[1,1]
    v_fract_f32 v177, v177
    v_pk_mul_f32 v[184:185], v[132:133], v[44:45] op_sel_hi:[1,0]
    v_fract_f32 v185, v185
    v_pk_mul_f32 v[192:193], v[132:133], v[44:45] op_sel:[0,1] op_sel_hi:[1,1]
    v_fract_f32 v193, v193
    v_pk_mul_f32 v[200:201], v[132:133], v[46:47] op_sel_hi:[1,0]
    v_fract_f32 v201, v201
    v_exp_f32 v176, v176
    v_cos_f32 v178, v177
    v_sin_f32 v179, v177
    v_exp_f32 v184, v184
    v_cos_f32 v186, v185
    v_sin_f32 v187, v185
    v_exp_f32 v192, v192
    v_cos_f32 v194, v193
    v_sin_f32 v195, v193
    v_exp_f32 v200, v200
    v_cos_f32 v202, v201
    v_sin_f32 v203, v201
    v_pk_mul_f32 v[148:149], v[146:147], v[144:145] op_sel_hi:[1,0]
    v_cvt_pk_bf16_f32 v60, v148, v149
    v_lshlrev_b32 v150, 16, v60
    v_and_b32 v151, 0xffff0000, v60
    v_pk_add_f32 v[148:149], v[148:149], v[150:151] neg_lo:[0,1] neg_hi:[0,1]
    v_cvt_pk_bf16_f32 v64, v148, v149
    v_pk_mul_f32 v[154:155], v[154:155], v[152:153] op_sel_hi:[1,0]
    v_pk_mul_f32 v[156:157], v[130:131], v[154:155] op_sel_hi:[1,0]
    v_pk_fma_f32 v[156:157], v[130:131], v[154:155], v[156:157] op_sel:[1,1,0] op_sel_hi:[0,1,1] neg_lo:[1,0,0] neg_hi:[1,0,1]
    v_cvt_pk_bf16_f32 v68, v156, v157
    v_lshlrev_b32 v158, 16, v68
    v_and_b32 v159, 0xffff0000, v68
    v_pk_add_f32 v[156:157], v[156:157], v[158:159] neg_lo:[0,1] neg_hi:[0,1]
    v_cvt_pk_bf16_f32 v72, v156, v157
    v_pk_mul_f32 v[162:163], v[162:163], v[160:161] op_sel_hi:[1,0]
    v_pk_mul_f32 v[164:165], v[130:131], v[162:163] op_sel_hi:[1,0]
    v_pk_fma_f32 v[164:165], v[130:131], v[162:163], v[164:165] op_sel:[1,1,0] op_sel_hi:[0,1,1] neg_lo:[1,0,0] neg_hi:[1,0,1]
    v_cvt_pk_bf16_f32 v76, v164, v165
    v_lshlrev_b32 v166, 16, v76
    v_and_b32 v167, 0xffff0000, v76
    v_pk_add_f32 v[164:165], v[164:165], v[166:167] neg_lo:[0,1] neg_hi:[0,1]
    v_cvt_pk_bf16_f32 v80, v164, v165
    v_pk_mul_f32 v[170:171], v[170:171], v[168:169] op_sel_hi:[1,0]
    v_pk_mul_f32 v[172:173], v[130:131], v[170:171] op_sel_hi:[1,0]
    v_pk_fma_f32 v[172:173], v[130:131], v[170:171], v[172:173] op_sel:[1,1,0] op_sel_hi:[0,1,1] neg_lo:[1,0,0] neg_hi:[1,0,1]
    v_cvt_pk_bf16_f32 v84, v172, v173
    v_lshlrev_b32 v174, 16, v84
    v_and_b32 v175, 0xffff0000, v84
    v_pk_add_f32 v[172:173], v[172:173], v[174:175] neg_lo:[0,1] neg_hi:[0,1]
    v_cvt_pk_bf16_f32 v88, v172, v173
    v_pk_mul_f32 v[144:145], v[136:137], v[46:47] op_sel:[0,1] op_sel_hi:[1,1]
    v_fract_f32 v145, v145
    v_pk_mul_f32 v[152:153], v[136:137], v[44:45] op_sel_hi:[1,0]
    v_fract_f32 v153, v153
    v_pk_mul_f32 v[160:161], v[136:137], v[44:45] op_sel:[0,1] op_sel_hi:[1,1]
    v_fract_f32 v161, v161
    v_pk_mul_f32 v[168:169], v[136:137], v[46:47] op_sel_hi:[1,0]
    v_fract_f32 v169, v169
    v_exp_f32 v144, v144
    v_cos_f32 v146, v145
    v_sin_f32 v147, v145
    v_exp_f32 v152, v152
    v_cos_f32 v154, v153
    v_sin_f32 v155, v153
    v_exp_f32 v160, v160
    v_cos_f32 v162, v161
    v_sin_f32 v163, v161
    v_exp_f32 v168, v168
    v_cos_f32 v170, v169
    v_sin_f32 v171, v169
    v_pk_mul_f32 v[180:181], v[178:179], v[176:177] op_sel_hi:[1,0]
    v_cvt_pk_bf16_f32 v61, v180, v181
    v_lshlrev_b32 v182, 16, v61
    v_and_b32 v183, 0xffff0000, v61
    v_pk_add_f32 v[180:181], v[180:181], v[182:183] neg_lo:[0,1] neg_hi:[0,1]
    v_cvt_pk_bf16_f32 v65, v180, v181
    v_pk_mul_f32 v[186:187], v[186:187], v[184:185] op_sel_hi:[1,0]
    v_pk_mul_f32 v[188:189], v[134:135], v[186:187] op_sel_hi:[1,0]
    v_pk_fma_f32 v[188:189], v[134:135], v[186:187], v[188:189] op_sel:[1,1,0] op_sel_hi:[0,1,1] neg_lo:[1,0,0] neg_hi:[1,0,1]
    v_cvt_pk_bf16_f32 v69, v188, v189
    v_lshlrev_b32 v190, 16, v69
    v_and_b32 v191, 0xffff0000, v69
    v_pk_add_f32 v[188:189], v[188:189], v[190:191] neg_lo:[0,1] neg_hi:[0,1]
    v_cvt_pk_bf16_f32 v73, v188, v189
    v_pk_mul_f32 v[194:195], v[194:195], v[192:193] op_sel_hi:[1,0]
    v_pk_mul_f32 v[196:197], v[134:135], v[194:195] op_sel_hi:[1,0]
    v_pk_fma_f32 v[196:197], v[134:135], v[194:195], v[196:197] op_sel:[1,1,0] op_sel_hi:[0,1,1] neg_lo:[1,0,0] neg_hi:[1,0,1]
    v_cvt_pk_bf16_f32 v77, v196, v197
    v_lshlrev_b32 v198, 16, v77
    v_and_b32 v199, 0xffff0000, v77
    v_pk_add_f32 v[196:197], v[196:197], v[198:199] neg_lo:[0,1] neg_hi:[0,1]
    v_cvt_pk_bf16_f32 v81, v196, v197
    v_pk_mul_f32 v[202:203], v[202:203], v[200:201] op_sel_hi:[1,0]
    v_pk_mul_f32 v[204:205], v[134:135], v[202:203] op_sel_hi:[1,0]
    v_pk_fma_f32 v[204:205], v[134:135], v[202:203], v[204:205] op_sel:[1,1,0] op_sel_hi:[0,1,1] neg_lo:[1,0,0] neg_hi:[1,0,1]
    v_cvt_pk_bf16_f32 v85, v204, v205
    v_lshlrev_b32 v206, 16, v85
    v_and_b32 v207, 0xffff0000, v85
    v_pk_add_f32 v[204:205], v[204:205], v[206:207] neg_lo:[0,1] neg_hi:[0,1]
    v_cvt_pk_bf16_f32 v89, v204, v205
    v_pk_mul_f32 v[176:177], v[140:141], v[46:47] op_sel:[0,1] op_sel_hi:[1,1]
    v_fract_f32 v177, v177
    v_pk_mul_f32 v[184:185], v[140:141], v[44:45] op_sel_hi:[1,0]
    v_fract_f32 v185, v185
    v_pk_mul_f32 v[192:193], v[140:141], v[44:45] op_sel:[0,1] op_sel_hi:[1,1]
    v_fract_f32 v193, v193
    v_pk_mul_f32 v[200:201], v[140:141], v[46:47] op_sel_hi:[1,0]
    v_fract_f32 v201, v201
    v_exp_f32 v176, v176
    v_cos_f32 v178, v177
    v_sin_f32 v179, v177
    v_exp_f32 v184, v184
    v_cos_f32 v186, v185
    v_sin_f32 v187, v185
    v_exp_f32 v192, v192
    v_cos_f32 v194, v193
    v_sin_f32 v195, v193
    v_exp_f32 v200, v200
    v_cos_f32 v202, v201
    v_sin_f32 v203, v201
    v_pk_mul_f32 v[148:149], v[146:147], v[144:145] op_sel_hi:[1,0]
    v_cvt_pk_bf16_f32 v62, v148, v149
    v_lshlrev_b32 v150, 16, v62
    v_and_b32 v151, 0xffff0000, v62
    v_pk_add_f32 v[148:149], v[148:149], v[150:151] neg_lo:[0,1] neg_hi:[0,1]
    v_cvt_pk_bf16_f32 v66, v148, v149
    v_pk_mul_f32 v[154:155], v[154:155], v[152:153] op_sel_hi:[1,0]
    v_pk_mul_f32 v[156:157], v[138:139], v[154:155] op_sel_hi:[1,0]
    v_pk_fma_f32 v[156:157], v[138:139], v[154:155], v[156:157] op_sel:[1,1,0] op_sel_hi:[0,1,1] neg_lo:[1,0,0] neg_hi:[1,0,1]
    v_cvt_pk_bf16_f32 v70, v156, v157
    v_lshlrev_b32 v158, 16, v70
    v_and_b32 v159, 0xffff0000, v70
    v_pk_add_f32 v[156:157], v[156:157], v[158:159] neg_lo:[0,1] neg_hi:[0,1]
    v_cvt_pk_bf16_f32 v74, v156, v157
    v_pk_mul_f32 v[162:163], v[162:163], v[160:161] op_sel_hi:[1,0]
    v_pk_mul_f32 v[164:165], v[138:139], v[162:163] op_sel_hi:[1,0]
    v_pk_fma_f32 v[164:165], v[138:139], v[162:163], v[164:165] op_sel:[1,1,0] op_sel_hi:[0,1,1] neg_lo:[1,0,0] neg_hi:[1,0,1]
    v_cvt_pk_bf16_f32 v78, v164, v165
    v_lshlrev_b32 v166, 16, v78
    v_and_b32 v167, 0xffff0000, v78
    v_pk_add_f32 v[164:165], v[164:165], v[166:167] neg_lo:[0,1] neg_hi:[0,1]
    v_cvt_pk_bf16_f32 v82, v164, v165
    v_pk_mul_f32 v[170:171], v[170:171], v[168:169] op_sel_hi:[1,0]
    v_pk_mul_f32 v[172:173], v[138:139], v[170:171] op_sel_hi:[1,0]
    v_pk_fma_f32 v[172:173], v[138:139], v[170:171], v[172:173] op_sel:[1,1,0] op_sel_hi:[0,1,1] neg_lo:[1,0,0] neg_hi:[1,0,1]
    v_cvt_pk_bf16_f32 v86, v172, v173
    v_lshlrev_b32 v174, 16, v86
    v_and_b32 v175, 0xffff0000, v86
    v_pk_add_f32 v[172:173], v[172:173], v[174:175] neg_lo:[0,1] neg_hi:[0,1]
    v_cvt_pk_bf16_f32 v90, v172, v173
    s_nop 15
    s_nop 7
    v_pk_mul_f32 v[180:181], v[178:179], v[176:177] op_sel_hi:[1,0]
    v_cvt_pk_bf16_f32 v63, v180, v181
    v_lshlrev_b32 v182, 16, v63
    v_and_b32 v183, 0xffff0000, v63
    v_pk_add_f32 v[180:181], v[180:181], v[182:183] neg_lo:[0,1] neg_hi:[0,1]
    v_cvt_pk_bf16_f32 v67, v180, v181
    v_pk_mul_f32 v[186:187], v[186:187], v[184:185] op_sel_hi:[1,0]
    v_pk_mul_f32 v[188:189], v[142:143], v[186:187] op_sel_hi:[1,0]
    v_pk_fma_f32 v[188:189], v[142:143], v[186:187], v[188:189] op_sel:[1,1,0] op_sel_hi:[0,1,1] neg_lo:[1,0,0] neg_hi:[1,0,1]
    v_cvt_pk_bf16_f32 v71, v188, v189
    v_lshlrev_b32 v190, 16, v71
    v_and_b32 v191, 0xffff0000, v71
    v_pk_add_f32 v[188:189], v[188:189], v[190:191] neg_lo:[0,1] neg_hi:[0,1]
    v_cvt_pk_bf16_f32 v75, v188, v189
    v_pk_mul_f32 v[194:195], v[194:195], v[192:193] op_sel_hi:[1,0]
    v_pk_mul_f32 v[196:197], v[142:143], v[194:195] op_sel_hi:[1,0]
    v_pk_fma_f32 v[196:197], v[142:143], v[194:195], v[196:197] op_sel:[1,1,0] op_sel_hi:[0,1,1] neg_lo:[1,0,0] neg_hi:[1,0,1]
    v_cvt_pk_bf16_f32 v79, v196, v197
    v_lshlrev_b32 v198, 16, v79
    v_and_b32 v199, 0xffff0000, v79
    v_pk_add_f32 v[196:197], v[196:197], v[198:199] neg_lo:[0,1] neg_hi:[0,1]
    v_cvt_pk_bf16_f32 v83, v196, v197
    v_pk_mul_f32 v[202:203], v[202:203], v[200:201] op_sel_hi:[1,0]
    v_pk_mul_f32 v[204:205], v[142:143], v[202:203] op_sel_hi:[1,0]
    v_pk_fma_f32 v[204:205], v[142:143], v[202:203], v[204:205] op_sel:[1,1,0] op_sel_hi:[0,1,1] neg_lo:[1,0,0] neg_hi:[1,0,1]
    v_cvt_pk_bf16_f32 v87, v204, v205
    v_lshlrev_b32 v206, 16, v87
    v_and_b32 v207, 0xffff0000, v87
    v_pk_add_f32 v[204:205], v[204:205], v[206:207] neg_lo:[0,1] neg_hi:[0,1]
    v_cvt_pk_bf16_f32 v91, v204, v205
    v_mfma_f32_16x16x32_bf16 v[96:99], v[68:71], v[60:63], v[96:99]
    v_mfma_f32_16x16x32_bf16 v[96:99], v[68:71], v[64:67], v[96:99]
    v_mfma_f32_16x16x32_bf16 v[96:99], v[72:75], v[60:63], v[96:99]
    v_mfma_f32_16x16x32_bf16 v[100:103], v[76:79], v[60:63], v[100:103]
    v_mfma_f32_16x16x32_bf16 v[100:103], v[76:79], v[64:67], v[100:103]
    v_mfma_f32_16x16x32_bf16 v[100:103], v[80:83], v[60:63], v[100:103]
    v_mfma_f32_16x16x32_bf16 v[104:107], v[84:87], v[60:63], v[104:107]
    v_mfma_f32_16x16x32_bf16 v[104:107], v[84:87], v[64:67], v[104:107]
    v_mfma_f32_16x16x32_bf16 v[104:107], v[88:91], v[60:63], v[104:107]
    s_nop 15
    s_nop 15
    s_mul_i32 s22, s96, 3072
    s_add_u32 s22, s22, 22656
    v_lshl_add_u32 v9, v234, 8, v232
    v_lshl_add_u32 v9, v233, 2, v9
    v_add_u32 v9, s22, v9
    ds_write_b32 v9, v96 offset:0
    ds_write_b32 v9, v97 offset:64
    ds_write_b32 v9, v98 offset:128
    ds_write_b32 v9, v99 offset:192
    ds_write_b32 v9, v100 offset:1024
    ds_write_b32 v9, v101 offset:1088
    ds_write_b32 v9, v102 offset:1152
    ds_write_b32 v9, v103 offset:1216
    ds_write_b32 v9, v104 offset:2048
    ds_write_b32 v9, v105 offset:2112
    ds_write_b32 v9, v106 offset:2176
    ds_write_b32 v9, v107 offset:2240
    v_lshlrev_b32 v1, 2, v225
    s_cmp_lg_u32 s18, 0
    s_cbranch_scc1 KA_GO
KA_POLL:
    buffer_load_dword v2, v1, s[88:91], 0 offen sc1
    s_waitcnt vmcnt(0)
    v_cmp_ne_u32 vcc, 4, v2
    s_cmp_eq_u64 vcc, 0
    s_cbranch_scc1 KA_GO
    s_sleep 4
    s_branch KA_POLL
KA_GO:
    s_barrier
    s_lshl_b32 s22, s20, 4
    v_lshl_add_u32 v3, v224, 13, s22
    v_add_u32 v4, 0x2000, v3
    buffer_load_dwordx4 v[32:35], v3, s[48:51], 0 offen sc1
    buffer_load_dword v36, v4, s[48:51], 0 offen sc1
    v_lshl_add_u32 v10, v224, 4, v232
    v_mov_b32 v60, 0
    v_mov_b32 v61, 0
    v_mov_b32 v62, 0
    v_mov_b32 v63, 0
    v_cmp_gt_u32 vcc, 30, v224
    s_and_saveexec_b64 s[36:37], vcc
    s_cbranch_execz KA_Z2
    ds_write_b128 v10, v[60:63] offset:12416
    ds_write_b128 v10, v[60:63] offset:17024
KA_Z2:
    s_mov_b64 exec, s[36:37]
    v_lshl_add_u32 v11, v224, 2, v232
    s_waitcnt lgkmcnt(0)
    s_barrier
    v_add_u32 v15, 22656, v11
    ds_read2st64_b32 v[64:65], v15 offset0:0 offset1:12
    ds_read2st64_b32 v[66:67], v15 offset0:24 offset1:36
    ds_read2st64_b32 v[68:69], v15 offset0:4 offset1:16
    ds_read2st64_b32 v[70:71], v15 offset0:28 offset1:40
    ds_read2st64_b32 v[72:73], v15 offset0:8 offset1:20
    ds_read2st64_b32 v[74:75], v15 offset0:32 offset1:44
    s_waitcnt lgkmcnt(0)
    v_add_f32 v64, v64, v65
    v_add_f32 v66, v66, v67
    v_add_f32 v64, v64, v66
    ds_write_b32 v11, v64 offset:19584
    v_add_f32 v68, v68, v69
    v_add_f32 v70, v70, v71
    v_add_f32 v68, v68, v70
    ds_write_b32 v11, v68 offset:20608
    v_add_f32 v72, v72, v73
    v_add_f32 v74, v74, v75
    v_add_f32 v72, v72, v74
    ds_write_b32 v11, v72 offset:21632
    v_lshrrev_b32 v9, 1, v234
    v_and_b32 v15, 1, v234
    v_sub_u32 v12, v9, v233
    v_lshlrev_b32 v12, 5, v12
    v_lshlrev_b32 v13, 4, v15
    v_sub_u32 v12, v12, v13
    s_lshl_b32 s22, s96, 7
    s_add_u32 s23, s22, 8816
    v_add3_u32 v226, v12, v232, s23
    v_add_u32 v12, 1, v233
    v_and_b32 v12, 1, v12
    v_lshlrev_b32 v13, 4, v9
    v_add_u32 v13, v13, v233
    v_lshlrev_b32 v14, 3, v15
    v_sub_u32 v13, v13, v14
    v_sub_u32 v13, v13, v12
    v_add_u32 v13, 9, v13
    v_lshlrev_b32 v13, 1, v13
    v_mul_u32_u24 v14, 4160, v12
    v_add_u32 v13, v13, v14
    v_add3_u32 v227, v13, v232, s22
    v_add_u32 v228, 1024, v227
    v_add_u32 v229, 2048, v227
    v_add_u32 v230, 3072, v227
    s_waitcnt lgkmcnt(0)
    s_barrier
    ds_read_b32 v64, v16
    ds_read_b32 v65, v17
    ds_read_b32 v66, v18
    ds_read_b32 v67, v19
    ds_read_b32 v68, v20
    ds_read_b32 v69, v21
    ds_read_b32 v70, v22
    ds_read_b32 v71, v23
    s_waitcnt lgkmcnt(0)
    v_cvt_pk_bf16_f32 v96, v64, v65
    v_lshlrev_b32 v72, 16, v96
    v_and_b32 v73, 0xffff0000, v96
    v_sub_f32 v64, v64, v72
    v_sub_f32 v65, v65, v73
    v_cvt_pk_bf16_f32 v100, v64, v65
    v_cvt_pk_bf16_f32 v97, v66, v67
    v_lshlrev_b32 v72, 16, v97
    v_and_b32 v73, 0xffff0000, v97
    v_sub_f32 v66, v66, v72
    v_sub_f32 v67, v67, v73
    v_cvt_pk_bf16_f32 v101, v66, v67
    v_cvt_pk_bf16_f32 v98, v68, v69
    v_lshlrev_b32 v72, 16, v98
    v_and_b32 v73, 0xffff0000, v98
    v_sub_f32 v68, v68, v72
    v_sub_f32 v69, v69, v73
    v_cvt_pk_bf16_f32 v102, v68, v69
    v_cvt_pk_bf16_f32 v99, v70, v71
    v_lshlrev_b32 v72, 16, v99
    v_and_b32 v73, 0xffff0000, v99
    v_sub_f32 v70, v70, v72
    v_sub_f32 v71, v71, v73
    v_cvt_pk_bf16_f32 v103, v70, v71
    ds_write_b128 v10, v[96:99] offset:8320
    ds_write_b128 v10, v[100:103] offset:12928
    s_waitcnt vmcnt(0)
    ds_write_b128 v10, v[32:35] offset:32
    v_alignbit_b32 v44, v33, v32, 16
    v_alignbit_b32 v45, v34, v33, 16
    v_alignbit_b32 v46, v35, v34, 16
    v_alignbit_b32 v47, v36, v35, 16
    ds_write_b128 v10, v[44:47] offset:4192
    v_mov_b32 v52, 0
    v_mov_b32 v53, 0
    v_mov_b32 v54, 0
    v_lshlrev_b32 v55, 16, v32
    v_cmp_eq_u32 vcc, 0, v224
    s_and_saveexec_b64 s[36:37], vcc
    s_cbranch_execz KA_Z1
    ds_write_b128 v232, v[60:63] offset:0
    ds_write_b128 v232, v[60:63] offset:16
    ds_write_b128 v232, v[60:63] offset:4160
    ds_write_b128 v232, v[52:55] offset:4176
KA_Z1:
    s_mov_b64 exec, s[36:37]
    s_waitcnt lgkmcnt(0)
    s_barrier
    ds_read2_b32 v[96:97], v227 offset0:0 offset1:1
    ds_read2_b32 v[98:99], v227 offset0:2 offset1:3
    ds_read_b128 v[60:63], v226 offset:0
    ds_read_b128 v[92:95], v226 offset:4608
    ds_read_b128 v[56:59], v226 offset:512
    ds_read_b128 v[88:91], v226 offset:5120
    ds_read_b128 v[52:55], v226 offset:1024
    ds_read_b128 v[84:87], v226 offset:5632
    ds_read_b128 v[48:51], v226 offset:1536
    ds_read_b128 v[80:83], v226 offset:6144
    ds_read_b128 v[44:47], v226 offset:2048
    ds_read_b128 v[76:79], v226 offset:6656
    ds_read_b128 v[40:43], v226 offset:2560
    ds_read_b128 v[72:75], v226 offset:7168
    s_waitcnt lgkmcnt(6)
    ds_read_b128 v[36:39], v226 offset:3072
    ds_read_b128 v[68:71], v226 offset:7680
    ds_read_b128 v[32:35], v226 offset:3584
    ds_read_b128 v[64:67], v226 offset:8192
    ds_read2_b32 v[100:101], v227 offset0:128 offset1:129
    ds_read2_b32 v[102:103], v227 offset0:130 offset1:131
    ds_read2_b32 v[104:105], v228 offset0:0 offset1:1
    ds_read2_b32 v[106:107], v228 offset0:2 offset1:3
    s_waitcnt lgkmcnt(6)
    ds_read2_b32 v[108:109], v228 offset0:128 offset1:129
    ds_read2_b32 v[110:111], v228 offset0:130 offset1:131
    ds_read2_b32 v[112:113], v229 offset0:0 offset1:1
    ds_read2_b32 v[114:115], v229 offset0:2 offset1:3
    ds_read2_b32 v[116:117], v229 offset0:128 offset1:129
    ds_read2_b32 v[118:119], v229 offset0:130 offset1:131
    ds_read2_b32 v[120:121], v230 offset0:0 offset1:1
    ds_read2_b32 v[122:123], v230 offset0:2 offset1:3
    s_waitcnt lgkmcnt(6)
    ds_read2_b32 v[124:125], v230 offset0:128 offset1:129
    ds_read2_b32 v[126:127], v230 offset0:130 offset1:131
    v_mov_b32 v0, 0
    v_mov_b32 v1, 0
    v_mov_b32 v2, 0
    v_mov_b32 v3, 0
    v_mov_b32 v4, 0
    v_mov_b32 v5, 0
    v_mov_b32 v6, 0
    v_mov_b32 v7, 0
    v_mov_b32 v8, 0
    v_mov_b32 v9, 0
    v_mov_b32 v10, 0
    v_mov_b32 v11, 0
    v_mov_b32 v12, 0
    v_mov_b32 v13, 0
    v_mov_b32 v14, 0
    v_mov_b32 v15, 0
    v_mov_b32 v16, 0
    v_mov_b32 v17, 0
    v_mov_b32 v18, 0
    v_mov_b32 v19, 0
    v_mov_b32 v20, 0
    v_mov_b32 v21, 0
    v_mov_b32 v22, 0
    v_mov_b32 v23, 0
    v_mov_b32 v24, 0
    v_mov_b32 v25, 0
    v_mov_b32 v26, 0
    v_mov_b32 v27, 0
    v_mov_b32 v28, 0
    v_mov_b32 v29, 0
    v_mov_b32 v30, 0
    v_mov_b32 v31, 0
    s_waitcnt lgkmcnt(0)
    s_nop 0
    v_mfma_f32_16x16x32_bf16 v[28:31], v[96:99], v[60:63], v[28:31]
    v_mfma_f32_16x16x32_bf16 v[28:31], v[96:99], v[92:95], v[28:31]
    ds_read2_b32 v[192:193], v227 offset0:16 offset1:17
    v_mfma_f32_16x16x32_bf16 v[24:27], v[96:99], v[56:59], v[24:27]
    v_mfma_f32_16x16x32_bf16 v[24:27], v[96:99], v[88:91], v[24:27]
    ds_read2_b32 v[194:195], v227 offset0:18 offset1:19
    v_mfma_f32_16x16x32_bf16 v[20:23], v[96:99], v[52:55], v[20:23]
    v_lshrrev_b32 v248, 3, v224
    v_mfma_f32_16x16x32_bf16 v[20:23], v[96:99], v[84:87], v[20:23]
    ds_read_b128 v[156:159], v226 offset:64
    v_mfma_f32_16x16x32_bf16 v[16:19], v[96:99], v[48:51], v[16:19]
    v_and_b32 v249, 7, v224
    v_mfma_f32_16x16x32_bf16 v[16:19], v[96:99], v[80:83], v[16:19]
    ds_read_b128 v[188:191], v226 offset:4672
    v_mfma_f32_16x16x32_bf16 v[12:15], v[96:99], v[44:47], v[12:15]
    v_mul_u32_u24 v244, 544, v249
    v_mfma_f32_16x16x32_bf16 v[12:15], v[96:99], v[76:79], v[12:15]
    ds_read_b128 v[152:155], v226 offset:576
    v_mfma_f32_16x16x32_bf16 v[8:11], v[96:99], v[40:43], v[8:11]
    v_lshl_add_u32 v244, v248, 1, v244
    v_mfma_f32_16x16x32_bf16 v[8:11], v[96:99], v[72:75], v[8:11]
    ds_read_b128 v[184:187], v226 offset:5184
    v_mfma_f32_16x16x32_bf16 v[4:7], v[96:99], v[36:39], v[4:7]
    v_add_u32 v244, 55424, v244
    v_mfma_f32_16x16x32_bf16 v[4:7], v[96:99], v[68:71], v[4:7]
    ds_read_b128 v[148:151], v226 offset:1088
    v_mfma_f32_16x16x32_bf16 v[0:3], v[96:99], v[32:35], v[0:3]
    v_add_u32 v244, v244, v232
    v_mfma_f32_16x16x32_bf16 v[0:3], v[96:99], v[64:67], v[0:3]
    ds_read_b128 v[180:183], v226 offset:5696
    v_mfma_f32_16x16x32_bf16 v[28:31], v[100:103], v[56:59], v[28:31]
    v_lshrrev_b32 v246, 2, v224
    v_mfma_f32_16x16x32_bf16 v[28:31], v[100:103], v[88:91], v[28:31]
    ds_read_b128 v[144:147], v226 offset:1600
    v_mfma_f32_16x16x32_bf16 v[24:27], v[100:103], v[52:55], v[24:27]
    v_and_b32 v247, 3, v224
    v_mfma_f32_16x16x32_bf16 v[24:27], v[100:103], v[84:87], v[24:27]
    ds_read_b128 v[176:179], v226 offset:6208
    v_mfma_f32_16x16x32_bf16 v[20:23], v[100:103], v[48:51], v[20:23]
    v_mul_u32_u24 v245, 68, v246
    v_mfma_f32_16x16x32_bf16 v[20:23], v[100:103], v[80:83], v[20:23]
    ds_read_b128 v[140:143], v226 offset:2112
    v_mfma_f32_16x16x32_bf16 v[16:19], v[100:103], v[44:47], v[16:19]
    v_lshl_add_u32 v245, v247, 4, v245
    v_mfma_f32_16x16x32_bf16 v[16:19], v[100:103], v[76:79], v[16:19]
    ds_read_b128 v[172:175], v226 offset:6720
    v_mfma_f32_16x16x32_bf16 v[12:15], v[100:103], v[40:43], v[12:15]
    v_add_u32 v245, 55424, v245
    v_mfma_f32_16x16x32_bf16 v[12:15], v[100:103], v[72:75], v[12:15]
    ds_read_b128 v[136:139], v226 offset:2624
    v_mfma_f32_16x16x32_bf16 v[8:11], v[100:103], v[36:39], v[8:11]
    v_add_u32 v245, v245, v232
    v_mfma_f32_16x16x32_bf16 v[8:11], v[100:103], v[68:71], v[8:11]
    ds_read_b128 v[168:171], v226 offset:7232
    v_mfma_f32_16x16x32_bf16 v[4:7], v[100:103], v[32:35], v[4:7]
    s_waitcnt lgkmcnt(6)
    ds_write_b16 v244, v236 offset:0
    v_mfma_f32_16x16x32_bf16 v[4:7], v[100:103], v[64:67], v[4:7]
    ds_read_b128 v[132:135], v226 offset:3136
    v_mfma_f32_16x16x32_bf16 v[28:31], v[104:107], v[52:55], v[28:31]
    ds_write_b16 v244, v240 offset:4352
    v_mfma_f32_16x16x32_bf16 v[28:31], v[104:107], v[84:87], v[28:31]
    ds_read_b128 v[164:167], v226 offset:7744
    v_mfma_f32_16x16x32_bf16 v[24:27], v[104:107], v[48:51], v[24:27]
    ds_write_b16_d16_hi v244, v236 offset:68
    v_mfma_f32_16x16x32_bf16 v[24:27], v[104:107], v[80:83], v[24:27]
    ds_read_b128 v[128:131], v226 offset:3648
    v_mfma_f32_16x16x32_bf16 v[20:23], v[104:107], v[44:47], v[20:23]
    ds_write_b16_d16_hi v244, v240 offset:4420
    v_mfma_f32_16x16x32_bf16 v[20:23], v[104:107], v[76:79], v[20:23]
    ds_read_b128 v[160:163], v226 offset:8256
    v_mfma_f32_16x16x32_bf16 v[16:19], v[104:107], v[40:43], v[16:19]
    s_waitcnt lgkmcnt(6)
    ds_write_b16 v244, v237 offset:136
    v_mfma_f32_16x16x32_bf16 v[16:19], v[104:107], v[72:75], v[16:19]
    ds_read2_b32 v[196:197], v227 offset0:144 offset1:145
    v_mfma_f32_16x16x32_bf16 v[12:15], v[104:107], v[36:39], v[12:15]
    ds_write_b16 v244, v241 offset:4488
    v_mfma_f32_16x16x32_bf16 v[12:15], v[104:107], v[68:71], v[12:15]
    ds_read2_b32 v[198:199], v227 offset0:146 offset1:147
    v_mfma_f32_16x16x32_bf16 v[8:11], v[104:107], v[32:35], v[8:11]
    ds_write_b16_d16_hi v244, v237 offset:204
    v_mfma_f32_16x16x32_bf16 v[8:11], v[104:107], v[64:67], v[8:11]
    ds_read2_b32 v[200:201], v228 offset0:16 offset1:17
    v_mfma_f32_16x16x32_bf16 v[28:31], v[108:111], v[48:51], v[28:31]
    ds_write_b16_d16_hi v244, v241 offset:4556
    v_mfma_f32_16x16x32_bf16 v[28:31], v[108:111], v[80:83], v[28:31]
    ds_read2_b32 v[202:203], v228 offset0:18 offset1:19
    v_mfma_f32_16x16x32_bf16 v[24:27], v[108:111], v[44:47], v[24:27]
    s_waitcnt lgkmcnt(6)
    ds_write_b16 v244, v238 offset:272
    v_mfma_f32_16x16x32_bf16 v[24:27], v[108:111], v[76:79], v[24:27]
    ds_read2_b32 v[204:205], v228 offset0:144 offset1:145
    v_mfma_f32_16x16x32_bf16 v[20:23], v[108:111], v[40:43], v[20:23]
    ds_write_b16 v244, v242 offset:4624
    v_mfma_f32_16x16x32_bf16 v[20:23], v[108:111], v[72:75], v[20:23]
    ds_read2_b32 v[206:207], v228 offset0:146 offset1:147
    v_mfma_f32_16x16x32_bf16 v[16:19], v[108:111], v[36:39], v[16:19]
    ds_write_b16_d16_hi v244, v238 offset:340
    v_mfma_f32_16x16x32_bf16 v[16:19], v[108:111], v[68:71], v[16:19]
    ds_read2_b32 v[208:209], v229 offset0:16 offset1:17
    v_mfma_f32_16x16x32_bf16 v[12:15], v[108:111], v[32:35], v[12:15]
    ds_write_b16_d16_hi v244, v242 offset:4692
    v_mfma_f32_16x16x32_bf16 v[12:15], v[108:111], v[64:67], v[12:15]
    ds_read2_b32 v[210:211], v229 offset0:18 offset1:19
    v_mfma_f32_16x16x32_bf16 v[28:31], v[112:115], v[44:47], v[28:31]
    s_waitcnt lgkmcnt(6)
    ds_write_b16 v244, v239 offset:408
    v_mfma_f32_16x16x32_bf16 v[28:31], v[112:115], v[76:79], v[28:31]
    ds_read2_b32 v[212:213], v229 offset0:144 offset1:145
    v_mfma_f32_16x16x32_bf16 v[24:27], v[112:115], v[40:43], v[24:27]
    ds_write_b16 v244, v243 offset:4760
    v_mfma_f32_16x16x32_bf16 v[24:27], v[112:115], v[72:75], v[24:27]
    ds_read2_b32 v[214:215], v229 offset0:146 offset1:147
    v_mfma_f32_16x16x32_bf16 v[20:23], v[112:115], v[36:39], v[20:23]
    ds_write_b16_d16_hi v244, v239 offset:476
    v_mfma_f32_16x16x32_bf16 v[20:23], v[112:115], v[68:71], v[20:23]
    ds_read2_b32 v[216:217], v230 offset0:16 offset1:17
    v_mfma_f32_16x16x32_bf16 v[16:19], v[112:115], v[32:35], v[16:19]
    ds_write_b16_d16_hi v244, v243 offset:4828
    v_mfma_f32_16x16x32_bf16 v[16:19], v[112:115], v[64:67], v[16:19]
    ds_read2_b32 v[218:219], v230 offset0:18 offset1:19
    v_mfma_f32_16x16x32_bf16 v[28:31], v[116:119], v[40:43], v[28:31]
    v_mfma_f32_16x16x32_bf16 v[28:31], v[116:119], v[72:75], v[28:31]
    s_waitcnt lgkmcnt(6)
    ds_read2_b32 v[220:221], v230 offset0:144 offset1:145
    v_mfma_f32_16x16x32_bf16 v[24:27], v[116:119], v[36:39], v[24:27]
    v_mfma_f32_16x16x32_bf16 v[24:27], v[116:119], v[68:71], v[24:27]
    ds_read2_b32 v[222:223], v230 offset0:146 offset1:147
    v_mfma_f32_16x16x32_bf16 v[20:23], v[116:119], v[32:35], v[20:23]
    v_mfma_f32_16x16x32_bf16 v[20:23], v[116:119], v[64:67], v[20:23]
    v_mfma_f32_16x16x32_bf16 v[28:31], v[120:123], v[36:39], v[28:31]
    v_mfma_f32_16x16x32_bf16 v[28:31], v[120:123], v[68:71], v[28:31]
    v_mfma_f32_16x16x32_bf16 v[24:27], v[120:123], v[32:35], v[24:27]
    v_mfma_f32_16x16x32_bf16 v[24:27], v[120:123], v[64:67], v[24:27]
    v_mfma_f32_16x16x32_bf16 v[28:31], v[124:127], v[32:35], v[28:31]
    v_mfma_f32_16x16x32_bf16 v[28:31], v[124:127], v[64:67], v[28:31]
    s_waitcnt lgkmcnt(0)
    s_barrier
    s_waitcnt lgkmcnt(0)
    v_mfma_f32_16x16x32_bf16 v[28:31], v[192:195], v[156:159], v[28:31]
    v_mfma_f32_16x16x32_bf16 v[28:31], v[192:195], v[188:191], v[28:31]
    v_mfma_f32_16x16x32_bf16 v[24:27], v[192:195], v[152:155], v[24:27]
    v_mfma_f32_16x16x32_bf16 v[24:27], v[192:195], v[184:187], v[24:27]
    v_mfma_f32_16x16x32_bf16 v[20:23], v[192:195], v[148:151], v[20:23]
    v_add_u32 v248, s25, v246
    v_mfma_f32_16x16x32_bf16 v[20:23], v[192:195], v[180:183], v[20:23]
    v_lshrrev_b32 v249, 5, v248
    v_mfma_f32_16x16x32_bf16 v[16:19], v[192:195], v[144:147], v[16:19]
    v_bfe_u32 v250, v248, 2, 1
    v_mfma_f32_16x16x32_bf16 v[16:19], v[192:195], v[176:179], v[16:19]
    v_lshl_add_u32 v249, v249, 1, v250
    v_mfma_f32_16x16x32_bf16 v[12:15], v[192:195], v[140:143], v[12:15]
    v_mul_lo_u32 v249, v249, s28
    v_mfma_f32_16x16x32_bf16 v[12:15], v[192:195], v[172:175], v[12:15]
    s_lshr_b32 s22, s24, 5
    v_mfma_f32_16x16x32_bf16 v[8:11], v[192:195], v[136:139], v[8:11]
    v_add_u32 v249, s22, v249
    v_mfma_f32_16x16x32_bf16 v[8:11], v[192:195], v[168:171], v[8:11]
    v_lshlrev_b32 v249, 10, v249
    v_mfma_f32_16x16x32_bf16 v[4:7], v[192:195], v[132:135], v[4:7]
    v_bfe_u32 v250, v248, 3, 2
    v_mfma_f32_16x16x32_bf16 v[4:7], v[192:195], v[164:167], v[4:7]
    v_and_b32 v251, 3, v248
    v_mfma_f32_16x16x32_bf16 v[0:3], v[192:195], v[128:131], v[0:3]
    v_lshl_add_u32 v250, v250, 2, v251
    v_mfma_f32_16x16x32_bf16 v[0:3], v[192:195], v[160:163], v[0:3]
    v_lshl_add_u32 v250, v247, 4, v250
    v_mfma_f32_16x16x32_bf16 v[28:31], v[196:199], v[152:155], v[28:31]
    v_lshl_add_u32 v249, v250, 4, v249
    v_mfma_f32_16x16x32_bf16 v[28:31], v[196:199], v[184:187], v[28:31]
    v_add_u32 v249, s29, v249
    v_mfma_f32_16x16x32_bf16 v[24:27], v[196:199], v[148:151], v[24:27]
    v_cmp_gt_u32 vcc, s26, v248
    v_mfma_f32_16x16x32_bf16 v[24:27], v[196:199], v[180:183], v[24:27]
    v_mov_b32 v250, 0x7ffffff0
    v_mfma_f32_16x16x32_bf16 v[20:23], v[196:199], v[144:147], v[20:23]
    v_cndmask_b32 v249, v250, v249, vcc
    v_mfma_f32_16x16x32_bf16 v[20:23], v[196:199], v[176:179], v[20:23]
    s_mov_b32 s38, s58
    v_mfma_f32_16x16x32_bf16 v[16:19], v[196:199], v[140:143], v[16:19]
    ds_read2_b32 v[252:253], v245 offset0:0 offset1:1
    v_mfma_f32_16x16x32_bf16 v[16:19], v[196:199], v[172:175], v[16:19]
    ds_read2_b32 v[254:255], v245 offset0:2 offset1:3
    v_mfma_f32_16x16x32_bf16 v[12:15], v[196:199], v[136:139], v[12:15]
    s_waitcnt lgkmcnt(0)
    v_mfma_f32_16x16x32_bf16 v[12:15], v[196:199], v[168:171], v[12:15]
    s_mov_b32 s36, s56
    v_mfma_f32_16x16x32_bf16 v[8:11], v[196:199], v[132:135], v[8:11]
    s_mov_b32 s37, s57
    v_mfma_f32_16x16x32_bf16 v[8:11], v[196:199], v[164:167], v[8:11]
    s_mov_b32 s39, s59
    v_mfma_f32_16x16x32_bf16 v[4:7], v[196:199], v[128:131], v[4:7]
    buffer_store_dwordx4 v[252:255], v249, s[36:39], 0 offen
    v_mfma_f32_16x16x32_bf16 v[4:7], v[196:199], v[160:163], v[4:7]
    s_nop 1
    v_mfma_f32_16x16x32_bf16 v[28:31], v[200:203], v[148:151], v[28:31]
    v_add_u32 v248, s31, v246
    v_mfma_f32_16x16x32_bf16 v[28:31], v[200:203], v[180:183], v[28:31]
    v_lshrrev_b32 v249, 5, v248
    v_mfma_f32_16x16x32_bf16 v[24:27], v[200:203], v[144:147], v[24:27]
    v_bfe_u32 v250, v248, 2, 1
    v_mfma_f32_16x16x32_bf16 v[24:27], v[200:203], v[176:179], v[24:27]
    v_lshl_add_u32 v249, v249, 1, v250
    v_mfma_f32_16x16x32_bf16 v[20:23], v[200:203], v[140:143], v[20:23]
    v_mul_lo_u32 v249, v249, s34
    v_mfma_f32_16x16x32_bf16 v[20:23], v[200:203], v[172:175], v[20:23]
    s_lshr_b32 s22, s30, 5
    v_mfma_f32_16x16x32_bf16 v[16:19], v[200:203], v[136:139], v[16:19]
    v_add_u32 v249, s22, v249
    v_mfma_f32_16x16x32_bf16 v[16:19], v[200:203], v[168:171], v[16:19]
    v_lshlrev_b32 v249, 10, v249
    v_mfma_f32_16x16x32_bf16 v[12:15], v[200:203], v[132:135], v[12:15]
    v_bfe_u32 v250, v248, 3, 2
    v_mfma_f32_16x16x32_bf16 v[12:15], v[200:203], v[164:167], v[12:15]
    v_and_b32 v251, 3, v248
    v_mfma_f32_16x16x32_bf16 v[8:11], v[200:203], v[128:131], v[8:11]
    v_lshl_add_u32 v250, v250, 2, v251
    v_mfma_f32_16x16x32_bf16 v[8:11], v[200:203], v[160:163], v[8:11]
    v_lshl_add_u32 v250, v247, 4, v250
    v_mfma_f32_16x16x32_bf16 v[28:31], v[204:207], v[144:147], v[28:31]
    v_lshl_add_u32 v249, v250, 4, v249
    v_mfma_f32_16x16x32_bf16 v[28:31], v[204:207], v[176:179], v[28:31]
    v_add_u32 v249, s35, v249
    v_mfma_f32_16x16x32_bf16 v[24:27], v[204:207], v[140:143], v[24:27]
    v_cmp_gt_u32 vcc, s32, v248
    v_mfma_f32_16x16x32_bf16 v[24:27], v[204:207], v[172:175], v[24:27]
    v_mov_b32 v250, 0x7ffffff0
    v_mfma_f32_16x16x32_bf16 v[20:23], v[204:207], v[136:139], v[20:23]
    v_cndmask_b32 v249, v250, v249, vcc
    v_mfma_f32_16x16x32_bf16 v[20:23], v[204:207], v[168:171], v[20:23]
    v_add_u32 v245, 4352, v245
    v_mfma_f32_16x16x32_bf16 v[16:19], v[204:207], v[132:135], v[16:19]
    s_cmp_ge_u32 s20, 184
    v_mfma_f32_16x16x32_bf16 v[16:19], v[204:207], v[164:167], v[16:19]
    s_cselect_b32 s38, 0, s58
    v_mfma_f32_16x16x32_bf16 v[12:15], v[204:207], v[128:131], v[12:15]
    ds_read2_b32 v[252:253], v245 offset0:0 offset1:1
    v_mfma_f32_16x16x32_bf16 v[12:15], v[204:207], v[160:163], v[12:15]
    ds_read2_b32 v[254:255], v245 offset0:2 offset1:3
    v_mfma_f32_16x16x32_bf16 v[28:31], v[208:211], v[140:143], v[28:31]
    s_waitcnt lgkmcnt(0)
    v_mfma_f32_16x16x32_bf16 v[28:31], v[208:211], v[172:175], v[28:31]
    s_mov_b32 s36, s56
    v_mfma_f32_16x16x32_bf16 v[24:27], v[208:211], v[136:139], v[24:27]
    s_mov_b32 s37, s57
    v_mfma_f32_16x16x32_bf16 v[24:27], v[208:211], v[168:171], v[24:27]
    s_mov_b32 s39, s59
    v_mfma_f32_16x16x32_bf16 v[20:23], v[208:211], v[132:135], v[20:23]
    buffer_store_dwordx4 v[252:255], v249, s[36:39], 0 offen
    v_mfma_f32_16x16x32_bf16 v[20:23], v[208:211], v[164:167], v[20:23]
    s_nop 1
    v_mfma_f32_16x16x32_bf16 v[16:19], v[208:211], v[128:131], v[16:19]
    v_mfma_f32_16x16x32_bf16 v[16:19], v[208:211], v[160:163], v[16:19]
    v_mfma_f32_16x16x32_bf16 v[28:31], v[212:215], v[136:139], v[28:31]
    v_mfma_f32_16x16x32_bf16 v[28:31], v[212:215], v[168:171], v[28:31]
    v_mfma_f32_16x16x32_bf16 v[24:27], v[212:215], v[132:135], v[24:27]
    v_mfma_f32_16x16x32_bf16 v[24:27], v[212:215], v[164:167], v[24:27]
    v_mfma_f32_16x16x32_bf16 v[20:23], v[212:215], v[128:131], v[20:23]
    v_mfma_f32_16x16x32_bf16 v[20:23], v[212:215], v[160:163], v[20:23]
    v_mfma_f32_16x16x32_bf16 v[28:31], v[216:219], v[132:135], v[28:31]
    v_mfma_f32_16x16x32_bf16 v[28:31], v[216:219], v[164:167], v[28:31]
    v_mfma_f32_16x16x32_bf16 v[24:27], v[216:219], v[128:131], v[24:27]
    v_mfma_f32_16x16x32_bf16 v[24:27], v[216:219], v[160:163], v[24:27]
    v_mfma_f32_16x16x32_bf16 v[28:31], v[220:223], v[128:131], v[28:31]
    v_mfma_f32_16x16x32_bf16 v[28:31], v[220:223], v[160:163], v[28:31]
    s_nop 15
    s_nop 15
    s_lshl_b32 s22, s96, 13
    s_add_u32 s22, s22, 22656
    v_lshl_add_u32 v40, v225, 4, v232
    v_add_u32 v41, s22, v40
    ds_write_b128 v41, v[0:3] offset:0
    ds_write_b128 v41, v[4:7] offset:1024
    ds_write_b128 v41, v[8:11] offset:2048
    ds_write_b128 v41, v[12:15] offset:3072
    ds_write_b128 v41, v[16:19] offset:4096
    ds_write_b128 v41, v[20:23] offset:5120
    ds_write_b128 v41, v[24:27] offset:6144
    ds_write_b128 v41, v[28:31] offset:7168
    s_lshl_b32 s22, s96, 11
    s_add_u32 s23, s22, 22656
    v_add_u32 v41, s23, v40
    v_lshlrev_b32 v42, 5, v233
    v_lshl_add_u32 v42, v234, 3, v42
    s_lshl_b32 s22, s96, 10
    v_add_u32 v42, s22, v42
    v_add_u32 v43, v42, v232
    s_lshl_b32 s22, s20, 12
    v_add_u32 v42, s22, v42
    s_waitcnt lgkmcnt(0)
    s_barrier
    ds_read_b128 v[64:67], v41 offset:0
    ds_read_b128 v[68:71], v41 offset:1024
    ds_read_b128 v[72:75], v41 offset:8192
    ds_read_b128 v[76:79], v41 offset:9216
    ds_read_b128 v[80:83], v41 offset:16384
    ds_read_b128 v[84:87], v41 offset:17408
    ds_read_b128 v[88:91], v41 offset:24576
    ds_read_b128 v[92:95], v41 offset:25600
    ds_read_b64 v[48:49], v43 offset:32
    ds_read_b64 v[50:51], v43 offset:544
    s_waitcnt lgkmcnt(0)
    v_add_f32 v64, v64, v72
    v_add_f32 v80, v80, v88
    v_add_f32 v65, v65, v73
    v_add_f32 v81, v81, v89
    v_add_f32 v66, v66, v74
    v_add_f32 v82, v82, v90
    v_add_f32 v67, v67, v75
    v_add_f32 v83, v83, v91
    v_add_f32 v68, v68, v76
    v_add_f32 v84, v84, v92
    v_add_f32 v69, v69, v77
    v_add_f32 v85, v85, v93
    v_add_f32 v70, v70, v78
    v_add_f32 v86, v86, v94
    v_add_f32 v71, v71, v79
    v_add_f32 v87, v87, v95
    v_add_f32 v0, v64, v80
    v_add_f32 v1, v65, v81
    v_add_f32 v2, v66, v82
    v_add_f32 v3, v67, v83
    v_add_f32 v4, v68, v84
    v_add_f32 v5, v69, v85
    v_add_f32 v6, v70, v86
    v_add_f32 v7, v71, v87
    v_cvt_pk_bf16_f32 v56, v0, v1
    v_cvt_pk_bf16_f32 v57, v2, v3
    v_lshlrev_b32 v0, 16, v56
    v_and_b32 v1, 0xffff0000, v56
    v_lshlrev_b32 v2, 16, v57
    v_and_b32 v3, 0xffff0000, v57
    v_lshlrev_b32 v58, 16, v48
    v_and_b32 v59, 0xffff0000, v48
    v_lshlrev_b32 v60, 16, v49
    v_and_b32 v61, 0xffff0000, v49
    v_mul_f32 v58, v58, v231
    v_mul_f32 v59, v59, v231
    v_mul_f32 v60, v60, v231
    v_mul_f32 v61, v61, v231
    v_cvt_pk_bf16_f32 v56, v58, v59
    v_cvt_pk_bf16_f32 v57, v60, v61
    v_lshlrev_b32 v58, 16, v56
    v_and_b32 v59, 0xffff0000, v56
    v_lshlrev_b32 v60, 16, v57
    v_and_b32 v61, 0xffff0000, v57
    v_add_f32 v0, v0, v58
    v_add_f32 v1, v1, v59
    v_add_f32 v2, v2, v60
    v_add_f32 v3, v3, v61
    v_cvt_pk_bf16_f32 v62, v0, v1
    v_cvt_pk_bf16_f32 v63, v2, v3
    buffer_store_dwordx2 v[62:63], v42, s[52:55], 0 offen offset:0
    v_cvt_pk_bf16_f32 v56, v4, v5
    v_cvt_pk_bf16_f32 v57, v6, v7
    v_lshlrev_b32 v4, 16, v56
    v_and_b32 v5, 0xffff0000, v56
    v_lshlrev_b32 v6, 16, v57
    v_and_b32 v7, 0xffff0000, v57
    v_lshlrev_b32 v58, 16, v50
    v_and_b32 v59, 0xffff0000, v50
    v_lshlrev_b32 v60, 16, v51
    v_and_b32 v61, 0xffff0000, v51
    v_mul_f32 v58, v58, v231
    v_mul_f32 v59, v59, v231
    v_mul_f32 v60, v60, v231
    v_mul_f32 v61, v61, v231
    v_cvt_pk_bf16_f32 v56, v58, v59
    v_cvt_pk_bf16_f32 v57, v60, v61
    v_lshlrev_b32 v58, 16, v56
    v_and_b32 v59, 0xffff0000, v56
    v_lshlrev_b32 v60, 16, v57
    v_and_b32 v61, 0xffff0000, v57
    v_add_f32 v4, v4, v58
    v_add_f32 v5, v5, v59
    v_add_f32 v6, v6, v60
    v_add_f32 v7, v7, v61
    v_cvt_pk_bf16_f32 v64, v4, v5
    v_cvt_pk_bf16_f32 v65, v6, v7
    buffer_store_dwordx2 v[64:65], v42, s[52:55], 0 offen offset:512
KA_END:
    s_endpgm
.globl k3_kernel
.p2align 8
.type k3_kernel,@function
k3_kernel:
    s_cmp_ge_u32 s2, 256
    s_cbranch_scc1 K3_END
    s_lshr_b32 s30, s2, 3
    s_and_b32 s3, s2, 7
    s_lshl_b32 s3, s3, 5
    s_lshr_b32 s2, s2, 3
    s_add_u32 s2, s2, s3
    s_load_dwordx2 s[4:5], s[0:1], 0
    s_load_dwordx2 s[6:7], s[0:1], 112
    s_waitcnt lgkmcnt(0)
    s_mov_b32 s8, s4
    s_and_b32 s9, s5, 0xffff
    s_mov_b32 s10, 0x200000
    s_mov_b32 s11, 0x20000
    s_add_u32 s12, s6, 0x200000
    s_addc_u32 s13, s7, 0
    s_and_b32 s13, s13, 0xffff
    s_mov_b32 s14, 0x200000
    s_mov_b32 s15, 0x20000
    s_add_u32 s20, s6, 0x400000
    s_addc_u32 s21, s7, 0
    s_and_b32 s21, s21, 0xffff
    s_mov_b32 s22, 0x200000
    s_mov_b32 s23, 0x20000
    s_add_u32 s24, s6, 0x600000
    s_addc_u32 s25, s7, 0
    s_and_b32 s25, s25, 0xffff
    s_mov_b32 s26, 0x200000
    s_mov_b32 s27, 0x20000
    s_lshl_b32 s3, s2, 4
    v_lshlrev_b32 v5, 12, v0
    v_add_u32 v5, s3, v5
    buffer_load_dwordx4 v[40:43], v5, s[12:15], 0 offen
    s_lshl_b32 s3, s2, 13
    v_lshlrev_b32 v1, 4, v0
    v_add_u32 v1, s3, v1
    buffer_load_dwordx4 v[4:7], v1, s[8:11], 0 offen
    v_and_b32 v44, 7, v0
    v_mul_u32_u24 v44, 65, v44
    v_lshrrev_b32 v45, 3, v0
    v_add_lshl_u32 v44, v44, v45, 4
    v_lshrrev_b32 v2, 6, v0
    v_and_b32 v3, 63, v0
    v_lshlrev_b32 v3, 4, v3
    v_lshl_add_u32 v3, v2, 1, v3
    s_waitcnt vmcnt(1)
    ds_write_b128 v44, v[40:43]
    s_waitcnt lgkmcnt(0)
    s_barrier
    ds_read_u16 v48, v3 offset:0
    ds_read_u16 v49, v3 offset:1040
    ds_read_u16 v50, v3 offset:2080
    ds_read_u16 v51, v3 offset:3120
    ds_read_u16 v52, v3 offset:4160
    ds_read_u16 v53, v3 offset:5200
    ds_read_u16 v54, v3 offset:6240
    ds_read_u16 v55, v3 offset:7280
    s_waitcnt vmcnt(0)
    v_lshlrev_b32 v8, 16, v4
    v_and_b32 v9, 0xffff0000, v4
    v_lshlrev_b32 v10, 16, v5
    v_and_b32 v11, 0xffff0000, v5
    v_lshlrev_b32 v12, 16, v6
    v_and_b32 v13, 0xffff0000, v6
    v_lshlrev_b32 v14, 16, v7
    v_and_b32 v15, 0xffff0000, v7
    s_waitcnt lgkmcnt(0)
    v_lshlrev_b32 v48, 16, v48
    v_add_f32 v8, v8, v48
    v_lshlrev_b32 v49, 16, v49
    v_add_f32 v9, v9, v49
    v_lshlrev_b32 v50, 16, v50
    v_add_f32 v10, v10, v50
    v_lshlrev_b32 v51, 16, v51
    v_add_f32 v11, v11, v51
    v_lshlrev_b32 v52, 16, v52
    v_add_f32 v12, v12, v52
    v_lshlrev_b32 v53, 16, v53
    v_add_f32 v13, v13, v53
    v_lshlrev_b32 v54, 16, v54
    v_add_f32 v14, v14, v54
    v_lshlrev_b32 v55, 16, v55
    v_add_f32 v15, v15, v55
    v_cvt_pk_bf16_f32 v40, v8, v9
    v_cvt_pk_bf16_f32 v41, v10, v11
    v_cvt_pk_bf16_f32 v42, v12, v13
    v_cvt_pk_bf16_f32 v43, v14, v15
    buffer_store_dwordx4 v[40:43], v1, s[20:23], 0 offen
    v_lshlrev_b32 v8, 16, v40
    v_and_b32 v9, 0xffff0000, v40
    v_lshlrev_b32 v10, 16, v41
    v_and_b32 v11, 0xffff0000, v41
    v_lshlrev_b32 v12, 16, v42
    v_and_b32 v13, 0xffff0000, v42
    v_lshlrev_b32 v14, 16, v43
    v_and_b32 v15, 0xffff0000, v43
    v_add_f32 v24, v8, v9
    v_add_f32 v25, v10, v11
    v_add_f32 v26, v12, v13
    v_add_f32 v27, v14, v15
    v_add_f32 v24, v24, v25
    v_add_f32 v26, v26, v27
    v_add_f32 v24, v24, v26
    s_nop 1
    v_add_f32_dpp v25, v24, v24 quad_perm:[1,0,3,2] row_mask:0xf bank_mask:0xf
    s_nop 1
    v_add_f32_dpp v25, v25, v25 quad_perm:[2,3,0,1] row_mask:0xf bank_mask:0xf
    s_nop 1
    v_add_f32_dpp v25, v25, v25 row_half_mirror row_mask:0xf bank_mask:0xf
    s_nop 1
    v_add_f32_dpp v25, v25, v25 row_mirror row_mask:0xf bank_mask:0xf
    s_nop 1
    v_add_f32_dpp v25, v25, v25 row_bcast:15 row_mask:0xa bank_mask:0xf
    s_nop 1
    v_add_f32_dpp v25, v25, v25 row_bcast:31 row_mask:0xc bank_mask:0xf
    s_nop 0
    v_readlane_b32 s16, v25, 63
    s_nop 1
    v_mov_b32 v28, s16
    v_mul_f32 v28, 0x3b000000, v28
    v_sub_f32 v31, v8, v28
    v_sub_f32 v32, v9, v28
    v_sub_f32 v33, v10, v28
    v_sub_f32 v34, v11, v28
    v_sub_f32 v35, v12, v28
    v_sub_f32 v36, v13, v28
    v_sub_f32 v37, v14, v28
    v_sub_f32 v38, v15, v28
    v_mul_f32 v24, v31, v31
    v_mul_f32 v25, v32, v32
    v_fmac_f32 v24, v33, v33
    v_fmac_f32 v25, v34, v34
    v_fmac_f32 v24, v35, v35
    v_fmac_f32 v25, v36, v36
    v_fmac_f32 v24, v37, v37
    v_fmac_f32 v25, v38, v38
    v_add_f32 v24, v24, v25
    s_nop 1
    v_add_f32_dpp v25, v24, v24 quad_perm:[1,0,3,2] row_mask:0xf bank_mask:0xf
    s_nop 1
    v_add_f32_dpp v25, v25, v25 quad_perm:[2,3,0,1] row_mask:0xf bank_mask:0xf
    s_nop 1
    v_add_f32_dpp v25, v25, v25 row_half_mirror row_mask:0xf bank_mask:0xf
    s_nop 1
    v_add_f32_dpp v25, v25, v25 row_mirror row_mask:0xf bank_mask:0xf
    s_nop 1
    v_add_f32_dpp v25, v25, v25 row_bcast:15 row_mask:0xa bank_mask:0xf
    s_nop 1
    v_add_f32_dpp v25, v25, v25 row_bcast:31 row_mask:0xc bank_mask:0xf
    s_nop 0
    v_readlane_b32 s17, v25, 63
    v_cvt_pk_bf16_f32 v29, v28, v28
    v_and_b32 v29, 0xffff0000, v29
    v_mov_b32 v24, s17
    v_mul_f32 v24, 0x3b000000, v24
    v_cvt_pk_bf16_f32 v24, v24, v24
    v_and_b32 v24, 0xffff0000, v24
    v_add_f32 v24, 0x3727c5ac, v24
    v_cvt_pk_bf16_f32 v24, v24, v24
    v_and_b32 v24, 0xffff0000, v24
    v_sqrt_f32 v24, v24
    s_nop 5
    v_cvt_pk_bf16_f32 v24, v24, v24
    v_and_b32 v24, 0xffff0000, v24
    v_rcp_f32 v30, v24
    v_sub_f32 v31, v8, v29
    v_sub_f32 v32, v9, v29
    v_sub_f32 v33, v10, v29
    v_sub_f32 v34, v11, v29
    v_sub_f32 v35, v12, v29
    v_sub_f32 v36, v13, v29
    v_sub_f32 v37, v14, v29
    v_sub_f32 v38, v15, v29
    v_cvt_pk_bf16_f32 v24, v31, v32
    v_cvt_pk_bf16_f32 v25, v33, v34
    v_cvt_pk_bf16_f32 v26, v35, v36
    v_cvt_pk_bf16_f32 v27, v37, v38
    v_lshlrev_b32 v31, 16, v24
    v_and_b32 v32, 0xffff0000, v24
    v_lshlrev_b32 v33, 16, v25
    v_and_b32 v34, 0xffff0000, v25
    v_lshlrev_b32 v35, 16, v26
    v_and_b32 v36, 0xffff0000, v26
    v_lshlrev_b32 v37, 16, v27
    v_and_b32 v38, 0xffff0000, v27
    v_mul_f32 v31, v31, v30
    v_mul_f32 v32, v32, v30
    v_mul_f32 v33, v33, v30
    v_mul_f32 v34, v34, v30
    v_mul_f32 v35, v35, v30
    v_mul_f32 v36, v36, v30
    v_mul_f32 v37, v37, v30
    v_mul_f32 v38, v38, v30
    v_cvt_pk_bf16_f32 v16, v31, v32
    v_cvt_pk_bf16_f32 v17, v33, v34
    v_cvt_pk_bf16_f32 v18, v35, v36
    v_cvt_pk_bf16_f32 v19, v37, v38
    v_lshlrev_b32 v8, 16, v16
    v_and_b32 v9, 0xffff0000, v16
    v_lshlrev_b32 v10, 16, v17
    v_and_b32 v11, 0xffff0000, v17
    v_lshlrev_b32 v12, 16, v18
    v_and_b32 v13, 0xffff0000, v18
    v_lshlrev_b32 v14, 16, v19
    v_and_b32 v15, 0xffff0000, v19
    v_add_f32 v24, v8, v9
    v_add_f32 v25, v10, v11
    v_add_f32 v26, v12, v13
    v_add_f32 v27, v14, v15
    v_add_f32 v24, v24, v25
    v_add_f32 v26, v26, v27
    v_add_f32 v24, v24, v26
    s_nop 1
    v_add_f32_dpp v25, v24, v24 quad_perm:[1,0,3,2] row_mask:0xf bank_mask:0xf
    s_nop 1
    v_add_f32_dpp v25, v25, v25 quad_perm:[2,3,0,1] row_mask:0xf bank_mask:0xf
    s_nop 1
    v_add_f32_dpp v25, v25, v25 row_half_mirror row_mask:0xf bank_mask:0xf
    s_nop 1
    v_add_f32_dpp v25, v25, v25 row_mirror row_mask:0xf bank_mask:0xf
    s_nop 1
    v_add_f32_dpp v25, v25, v25 row_bcast:15 row_mask:0xa bank_mask:0xf
    s_nop 1
    v_add_f32_dpp v25, v25, v25 row_bcast:31 row_mask:0xc bank_mask:0xf
    s_nop 0
    v_readlane_b32 s16, v25, 63
    s_nop 1
    v_mov_b32 v28, s16
    v_mul_f32 v28, 0x3b000000, v28
    v_sub_f32 v31, v8, v28
    v_sub_f32 v32, v9, v28
    v_sub_f32 v33, v10, v28
    v_sub_f32 v34, v11, v28
    v_sub_f32 v35, v12, v28
    v_sub_f32 v36, v13, v28
    v_sub_f32 v37, v14, v28
    v_sub_f32 v38, v15, v28
    v_mul_f32 v24, v31, v31
    v_mul_f32 v25, v32, v32
    v_fmac_f32 v24, v33, v33
    v_fmac_f32 v25, v34, v34
    v_fmac_f32 v24, v35, v35
    v_fmac_f32 v25, v36, v36
    v_fmac_f32 v24, v37, v37
    v_fmac_f32 v25, v38, v38
    v_add_f32 v24, v24, v25
    s_nop 1
    v_add_f32_dpp v25, v24, v24 quad_perm:[1,0,3,2] row_mask:0xf bank_mask:0xf
    s_nop 1
    v_add_f32_dpp v25, v25, v25 quad_perm:[2,3,0,1] row_mask:0xf bank_mask:0xf
    s_nop 1
    v_add_f32_dpp v25, v25, v25 row_half_mirror row_mask:0xf bank_mask:0xf
    s_nop 1
    v_add_f32_dpp v25, v25, v25 row_mirror row_mask:0xf bank_mask:0xf
    s_nop 1
    v_add_f32_dpp v25, v25, v25 row_bcast:15 row_mask:0xa bank_mask:0xf
    s_nop 1
    v_add_f32_dpp v25, v25, v25 row_bcast:31 row_mask:0xc bank_mask:0xf
    s_nop 0
    v_readlane_b32 s17, v25, 63
    v_cvt_pk_bf16_f32 v29, v28, v28
    v_and_b32 v29, 0xffff0000, v29
    v_mov_b32 v24, s17
    v_mul_f32 v24, 0x3b000000, v24
    v_cvt_pk_bf16_f32 v24, v24, v24
    v_and_b32 v24, 0xffff0000, v24
    v_add_f32 v24, 0x3727c5ac, v24
    v_cvt_pk_bf16_f32 v24, v24, v24
    v_and_b32 v24, 0xffff0000, v24
    v_sqrt_f32 v24, v24
    s_nop 5
    v_cvt_pk_bf16_f32 v24, v24, v24
    v_and_b32 v24, 0xffff0000, v24
    v_rcp_f32 v30, v24
    v_sub_f32 v31, v8, v29
    v_sub_f32 v32, v9, v29
    v_sub_f32 v33, v10, v29
    v_sub_f32 v34, v11, v29
    v_sub_f32 v35, v12, v29
    v_sub_f32 v36, v13, v29
    v_sub_f32 v37, v14, v29
    v_sub_f32 v38, v15, v29
    v_cvt_pk_bf16_f32 v24, v31, v32
    v_cvt_pk_bf16_f32 v25, v33, v34
    v_cvt_pk_bf16_f32 v26, v35, v36
    v_cvt_pk_bf16_f32 v27, v37, v38
    v_lshlrev_b32 v31, 16, v24
    v_and_b32 v32, 0xffff0000, v24
    v_lshlrev_b32 v33, 16, v25
    v_and_b32 v34, 0xffff0000, v25
    v_lshlrev_b32 v35, 16, v26
    v_and_b32 v36, 0xffff0000, v26
    v_lshlrev_b32 v37, 16, v27
    v_and_b32 v38, 0xffff0000, v27
    v_mul_f32 v31, v31, v30
    v_mul_f32 v32, v32, v30
    v_mul_f32 v33, v33, v30
    v_mul_f32 v34, v34, v30
    v_mul_f32 v35, v35, v30
    v_mul_f32 v36, v36, v30
    v_mul_f32 v37, v37, v30
    v_mul_f32 v38, v38, v30
    v_cvt_pk_bf16_f32 v16, v31, v32
    v_cvt_pk_bf16_f32 v17, v33, v34
    v_cvt_pk_bf16_f32 v18, v35, v36
    v_cvt_pk_bf16_f32 v19, v37, v38
    s_lshr_b32 s3, s2, 1
    s_lshl_b32 s3, s3, 14
    s_and_b32 s28, s2, 1
    s_lshl_b32 s28, s28, 7
    s_add_u32 s3, s3, s28
    v_and_b32 v44, 63, v0
    v_lshrrev_b32 v45, 2, v44
    v_lshlrev_b32 v45, 10, v45
    v_and_b32 v44, 3, v44
    v_lshl_add_u32 v45, v44, 8, v45
    v_lshl_add_u32 v45, v2, 4, v45
    v_add_u32 v45, s3, v45
    buffer_store_dwordx4 v[16:19], v45, s[24:27], 0 offen
K3_END:
    s_endpgm
.globl k4_kernel
.p2align 8
.type k4_kernel,@function
k4_kernel:
    s_cmp_ge_u32 s2, 240
    s_cbranch_scc1 K4_END
    s_load_dwordx2 s[4:5], s[0:1], 112
    s_load_dwordx2 s[6:7], s[0:1], 72
    s_and_b32 s20, s2, 7
    s_lshl_b32 s20, s20, 1
    s_bfe_u32 s21, s2, 0x10003
    s_add_u32 s20, s20, s21
    s_lshr_b32 s21, s2, 4
    s_lshl_b32 s20, s20, 7
    s_mul_i32 s21, s21, 96
    v_lshrrev_b32 v1, 6, v0
    s_nop 0
    v_readfirstlane_b32 s22, v1
    v_and_b32 v2, 63, v0
    v_and_b32 v3, 15, v2
    v_lshrrev_b32 v4, 4, v2
    s_waitcnt lgkmcnt(0)
    s_mov_b32 s8, s4
    s_and_b32 s9, s5, 0xffff
    s_mov_b32 s10, 0x10000000
    s_mov_b32 s11, 0x20000
    s_mov_b32 s12, s6
    s_and_b32 s13, s7, 0xffff
    s_mov_b32 s14, 0xac0
    s_mov_b32 s15, 0x20000
    v_lshlrev_b32 v28, 4, v2
    s_mul_i32 s30, s21, 0x5555556
    s_lshr_b32 s30, s2, 4
    s_mul_i32 s30, s30, 6
    s_lshl_b32 s30, s30, 14
    s_add_u32 s30, s30, 8388608
    s_lshl_b32 s31, s20, 10
    s_add_u32 s31, s31, 6291456
    s_mov_b32 s32, 0
    s_mov_b32 s33, 0
    s_mov_b32 s34, 0
    s_mov_b32 s35, 0
    s_mov_b32 s36, 0
    s_mov_b32 s37, 0
    s_mov_b32 s38, 0
    s_cmp_lg_u32 s22, 0
    s_cbranch_scc1 K4_PW0
    s_add_u32 s32, s30, 0
    s_add_u32 s33, s30, 65536
    s_add_u32 s34, s31, 32768
    s_add_u32 s35, s31, 98304
    s_add_u32 s36, s30, 33792
    s_add_u32 s37, s31, 1024
    s_add_u32 s38, s31, 66560
K4_PW0:
    s_cmp_lg_u32 s22, 1
    s_cbranch_scc1 K4_PW1
    s_add_u32 s32, s30, 16384
    s_add_u32 s33, s30, 81920
    s_add_u32 s34, s31, 49152
    s_add_u32 s35, s31, 114688
    s_add_u32 s36, s30, 50176
    s_add_u32 s37, s31, 17408
    s_add_u32 s38, s31, 82944
K4_PW1:
    s_cmp_lg_u32 s22, 2
    s_cbranch_scc1 K4_PW2
    s_add_u32 s32, s30, 32768
    s_add_u32 s33, s31, 0
    s_add_u32 s34, s31, 65536
    s_add_u32 s35, s30, 1024
    s_add_u32 s36, s30, 66560
    s_add_u32 s37, s31, 33792
    s_add_u32 s38, s31, 99328
K4_PW2:
    s_cmp_lg_u32 s22, 3
    s_cbranch_scc1 K4_PW3
    s_add_u32 s32, s30, 49152
    s_add_u32 s33, s31, 16384
    s_add_u32 s34, s31, 81920
    s_add_u32 s35, s30, 17408
    s_add_u32 s36, s30, 82944
    s_add_u32 s37, s31, 50176
    s_add_u32 s38, s31, 115712
K4_PW3:
    s_lshl_b32 s24, s22, 10
    s_mov_b32 s29, 0
    v_lshlrev_b32 v7, 3, v4
    v_add_u32 v7, s21, v7
    v_lshlrev_b32 v7, 1, v7
    buffer_load_dwordx4 v[16:19], v7, s[12:15], 0 offen offset:0
    buffer_load_dwordx4 v[20:23], v7, s[12:15], 0 offen offset:64
    buffer_load_dwordx4 v[24:27], v7, s[12:15], 0 offen offset:128
    s_add_u32 s25, s29, 0
    s_and_b32 s25, s25, 7
    s_lshl_b32 s25, s25, 11
    s_add_u32 s39, s32, s25
    s_add_u32 m0, s24, 0
    s_nop 0
    buffer_load_dwordx4 v28, s[8:11], s39 offen lds
    s_add_u32 s39, s33, s25
    s_add_u32 m0, s24, 4096
    s_nop 0
    buffer_load_dwordx4 v28, s[8:11], s39 offen lds
    s_add_u32 s39, s34, s25
    s_add_u32 m0, s24, 8192
    s_nop 0
    buffer_load_dwordx4 v28, s[8:11], s39 offen lds
    s_add_u32 s39, s35, s25
    s_add_u32 m0, s24, 12288
    s_nop 0
    buffer_load_dwordx4 v28, s[8:11], s39 offen lds
    s_add_u32 s39, s36, s25
    s_add_u32 m0, s24, 16384
    s_nop 0
    buffer_load_dwordx4 v28, s[8:11], s39 offen lds
    s_add_u32 s39, s37, s25
    s_add_u32 m0, s24, 20480
    s_nop 0
    buffer_load_dwordx4 v28, s[8:11], s39 offen lds
    s_add_u32 s39, s38, s25
    s_add_u32 m0, s24, 24576
    s_nop 0
    buffer_load_dwordx4 v28, s[8:11], s39 offen lds
    s_add_u32 s25, s29, 1
    s_and_b32 s25, s25, 7
    s_lshl_b32 s25, s25, 11
    s_add_u32 s39, s32, s25
    s_add_u32 m0, s24, 28672
    s_nop 0
    buffer_load_dwordx4 v28, s[8:11], s39 offen lds
    s_add_u32 s39, s33, s25
    s_add_u32 m0, s24, 32768
    s_nop 0
    buffer_load_dwordx4 v28, s[8:11], s39 offen lds
    s_add_u32 s39, s34, s25
    s_add_u32 m0, s24, 36864
    s_nop 0
    buffer_load_dwordx4 v28, s[8:11], s39 offen lds
    s_add_u32 s39, s35, s25
    s_add_u32 m0, s24, 40960
    s_nop 0
    buffer_load_dwordx4 v28, s[8:11], s39 offen lds
    s_add_u32 s39, s36, s25
    s_add_u32 m0, s24, 45056
    s_nop 0
    buffer_load_dwordx4 v28, s[8:11], s39 offen lds
    s_add_u32 s39, s37, s25
    s_add_u32 m0, s24, 49152
    s_nop 0
    buffer_load_dwordx4 v28, s[8:11], s39 offen lds
    s_add_u32 s39, s38, s25
    s_add_u32 m0, s24, 53248
    s_nop 0
    buffer_load_dwordx4 v28, s[8:11], s39 offen lds
    s_add_u32 s25, s29, 2
    s_and_b32 s25, s25, 7
    s_lshl_b32 s25, s25, 11
    s_add_u32 s39, s32, s25
    s_add_u32 m0, s24, 57344
    s_nop 0
    buffer_load_dwordx4 v28, s[8:11], s39 offen lds
    s_add_u32 s39, s33, s25
    s_add_u32 m0, s24, 61440
    s_nop 0
    buffer_load_dwordx4 v28, s[8:11], s39 offen lds
    s_add_u32 s39, s34, s25
    s_add_u32 m0, s24, 65536
    s_nop 0
    buffer_load_dwordx4 v28, s[8:11], s39 offen lds
    s_add_u32 s39, s35, s25
    s_add_u32 m0, s24, 69632
    s_nop 0
    buffer_load_dwordx4 v28, s[8:11], s39 offen lds
    s_add_u32 s39, s36, s25
    s_add_u32 m0, s24, 73728
    s_nop 0
    buffer_load_dwordx4 v28, s[8:11], s39 offen lds
    s_add_u32 s39, s37, s25
    s_add_u32 m0, s24, 77824
    s_nop 0
    buffer_load_dwordx4 v28, s[8:11], s39 offen lds
    s_add_u32 s39, s38, s25
    s_add_u32 m0, s24, 81920
    s_nop 0
    buffer_load_dwordx4 v28, s[8:11], s39 offen lds
    v_mov_b32 v32, 0
    v_mov_b32 v33, 0
    v_mov_b32 v34, 0
    v_mov_b32 v35, 0
    v_mov_b32 v36, 0
    v_mov_b32 v37, 0
    v_mov_b32 v38, 0
    v_mov_b32 v39, 0
    v_mov_b32 v40, 0
    v_mov_b32 v41, 0
    v_mov_b32 v42, 0
    v_mov_b32 v43, 0
    v_mov_b32 v44, 0
    v_mov_b32 v45, 0
    v_mov_b32 v46, 0
    v_mov_b32 v47, 0
    v_mov_b32 v48, 0
    v_mov_b32 v49, 0
    v_mov_b32 v50, 0
    v_mov_b32 v51, 0
    v_mov_b32 v52, 0
    v_mov_b32 v53, 0
    v_mov_b32 v54, 0
    v_mov_b32 v55, 0
    v_mov_b32 v56, 0
    v_mov_b32 v57, 0
    v_mov_b32 v58, 0
    v_mov_b32 v59, 0
    v_mov_b32 v60, 0
    v_mov_b32 v61, 0
    v_mov_b32 v62, 0
    v_mov_b32 v63, 0
    v_mov_b32 v64, 0
    v_mov_b32 v65, 0
    v_mov_b32 v66, 0
    v_mov_b32 v67, 0
    v_mov_b32 v68, 0
    v_mov_b32 v69, 0
    v_mov_b32 v70, 0
    v_mov_b32 v71, 0
    v_mov_b32 v72, 0
    v_mov_b32 v73, 0
    v_mov_b32 v74, 0
    v_mov_b32 v75, 0
    v_mov_b32 v76, 0
    v_mov_b32 v77, 0
    v_mov_b32 v78, 0
    v_mov_b32 v79, 0
    s_lshl_b32 s26, s22, 11
    v_add_u32 v29, 0, v28
    v_add_u32 v144, s26, v29
    v_add_u32 v30, 57344, v28
    v_add_u32 v145, s26, v30
    v_add_u32 v31, 114688, v28
    v_add_u32 v146, s26, v31
    s_waitcnt vmcnt(7)
    s_barrier
    ds_read_b128 v[80:83], v29 offset:0
    ds_read_b128 v[84:87], v29 offset:1024
    ds_read_b128 v[88:91], v29 offset:2048
    ds_read_b128 v[92:95], v29 offset:3072
    ds_read_b128 v[96:99], v29 offset:4096
    ds_read_b128 v[100:103], v29 offset:5120
    ds_read_b128 v[104:107], v144 offset:6144
    ds_read_b128 v[108:111], v144 offset:7168
    s_waitcnt lgkmcnt(0)
    v_mfma_f32_16x16x32_bf16 v[32:35], v[80:83], v[104:107], v[32:35]
    s_add_u32 s25, s29, 3
    v_mfma_f32_16x16x32_bf16 v[36:39], v[84:87], v[104:107], v[36:39]
    s_and_b32 s25, s25, 7
    ds_read_b128 v[112:115], v29 offset:14336
    v_mfma_f32_16x16x32_bf16 v[40:43], v[88:91], v[104:107], v[40:43]
    s_lshl_b32 s25, s25, 11
    ds_read_b128 v[116:119], v29 offset:15360
    v_mfma_f32_16x16x32_bf16 v[44:47], v[92:95], v[104:107], v[44:47]
    s_add_u32 s39, s32, s25
    ds_read_b128 v[120:123], v29 offset:16384
    v_mfma_f32_16x16x32_bf16 v[48:51], v[96:99], v[104:107], v[48:51]
    s_add_u32 m0, s24, 86016
    ds_read_b128 v[124:127], v29 offset:17408
    v_mfma_f32_16x16x32_bf16 v[52:55], v[100:103], v[104:107], v[52:55]
    buffer_load_dwordx4 v28, s[8:11], s39 offen lds
    ds_read_b128 v[128:131], v29 offset:18432
    v_mfma_f32_16x16x32_bf16 v[56:59], v[80:83], v[108:111], v[56:59]
    s_add_u32 s39, s33, s25
    ds_read_b128 v[132:135], v29 offset:19456
    v_mfma_f32_16x16x32_bf16 v[60:63], v[84:87], v[108:111], v[60:63]
    s_add_u32 m0, s24, 90112
    ds_read_b128 v[136:139], v144 offset:20480
    v_mfma_f32_16x16x32_bf16 v[64:67], v[88:91], v[108:111], v[64:67]
    buffer_load_dwordx4 v28, s[8:11], s39 offen lds
    ds_read_b128 v[140:143], v144 offset:21504
    v_mfma_f32_16x16x32_bf16 v[68:71], v[92:95], v[108:111], v[68:71]
    s_add_u32 s39, s34, s25
    v_mfma_f32_16x16x32_bf16 v[72:75], v[96:99], v[108:111], v[72:75]
    s_add_u32 m0, s24, 94208
    v_mfma_f32_16x16x32_bf16 v[76:79], v[100:103], v[108:111], v[76:79]
    buffer_load_dwordx4 v28, s[8:11], s39 offen lds
    s_waitcnt lgkmcnt(0)
    v_mfma_f32_16x16x32_bf16 v[32:35], v[112:115], v[136:139], v[32:35]
    s_add_u32 s39, s35, s25
    v_mfma_f32_16x16x32_bf16 v[36:39], v[116:119], v[136:139], v[36:39]
    s_add_u32 m0, s24, 98304
    ds_read_b128 v[80:83], v29 offset:28672
    v_mfma_f32_16x16x32_bf16 v[40:43], v[120:123], v[136:139], v[40:43]
    buffer_load_dwordx4 v28, s[8:11], s39 offen lds
    ds_read_b128 v[84:87], v29 offset:29696
    v_mfma_f32_16x16x32_bf16 v[44:47], v[124:127], v[136:139], v[44:47]
    s_add_u32 s39, s36, s25
    ds_read_b128 v[88:91], v29 offset:30720
    v_mfma_f32_16x16x32_bf16 v[48:51], v[128:131], v[136:139], v[48:51]
    s_add_u32 m0, s24, 102400
    ds_read_b128 v[92:95], v29 offset:31744
    v_mfma_f32_16x16x32_bf16 v[52:55], v[132:135], v[136:139], v[52:55]
    buffer_load_dwordx4 v28, s[8:11], s39 offen lds
    ds_read_b128 v[96:99], v29 offset:32768
    v_mfma_f32_16x16x32_bf16 v[56:59], v[112:115], v[140:143], v[56:59]
    s_add_u32 s39, s37, s25
    ds_read_b128 v[100:103], v29 offset:33792
    v_mfma_f32_16x16x32_bf16 v[60:63], v[116:119], v[140:143], v[60:63]
    s_add_u32 m0, s24, 106496
    ds_read_b128 v[104:107], v144 offset:34816
    v_mfma_f32_16x16x32_bf16 v[64:67], v[120:123], v[140:143], v[64:67]
    buffer_load_dwordx4 v28, s[8:11], s39 offen lds
    ds_read_b128 v[108:111], v144 offset:35840
    v_mfma_f32_16x16x32_bf16 v[68:71], v[124:127], v[140:143], v[68:71]
    s_add_u32 s39, s38, s25
    v_mfma_f32_16x16x32_bf16 v[72:75], v[128:131], v[140:143], v[72:75]
    s_add_u32 m0, s24, 110592
    v_mfma_f32_16x16x32_bf16 v[76:79], v[132:135], v[140:143], v[76:79]
    buffer_load_dwordx4 v28, s[8:11], s39 offen lds
    s_waitcnt vmcnt(7)
    s_barrier
    s_waitcnt lgkmcnt(0)
    v_mfma_f32_16x16x32_bf16 v[32:35], v[80:83], v[104:107], v[32:35]
    s_add_u32 s25, s29, 4
    v_mfma_f32_16x16x32_bf16 v[36:39], v[84:87], v[104:107], v[36:39]
    s_and_b32 s25, s25, 7
    ds_read_b128 v[112:115], v29 offset:43008
    v_mfma_f32_16x16x32_bf16 v[40:43], v[88:91], v[104:107], v[40:43]
    s_lshl_b32 s25, s25, 11
    ds_read_b128 v[116:119], v29 offset:44032
    v_mfma_f32_16x16x32_bf16 v[44:47], v[92:95], v[104:107], v[44:47]
    s_add_u32 s39, s32, s25
    ds_read_b128 v[120:123], v29 offset:45056
    v_mfma_f32_16x16x32_bf16 v[48:51], v[96:99], v[104:107], v[48:51]
    s_add_u32 m0, s24, 114688
    ds_read_b128 v[124:127], v29 offset:46080
    v_mfma_f32_16x16x32_bf16 v[52:55], v[100:103], v[104:107], v[52:55]
    buffer_load_dwordx4 v28, s[8:11], s39 offen lds
    ds_read_b128 v[128:131], v29 offset:47104
    v_mfma_f32_16x16x32_bf16 v[56:59], v[80:83], v[108:111], v[56:59]
    s_add_u32 s39, s33, s25
    ds_read_b128 v[132:135], v29 offset:48128
    v_mfma_f32_16x16x32_bf16 v[60:63], v[84:87], v[108:111], v[60:63]
    s_add_u32 m0, s24, 118784
    ds_read_b128 v[136:139], v144 offset:49152
    v_mfma_f32_16x16x32_bf16 v[64:67], v[88:91], v[108:111], v[64:67]
    buffer_load_dwordx4 v28, s[8:11], s39 offen lds
    ds_read_b128 v[140:143], v144 offset:50176
    v_mfma_f32_16x16x32_bf16 v[68:71], v[92:95], v[108:111], v[68:71]
    s_add_u32 s39, s34, s25
    v_mfma_f32_16x16x32_bf16 v[72:75], v[96:99], v[108:111], v[72:75]
    s_add_u32 m0, s24, 122880
    v_mfma_f32_16x16x32_bf16 v[76:79], v[100:103], v[108:111], v[76:79]
    buffer_load_dwordx4 v28, s[8:11], s39 offen lds
    s_waitcnt lgkmcnt(0)
    v_mfma_f32_16x16x32_bf16 v[32:35], v[112:115], v[136:139], v[32:35]
    s_add_u32 s39, s35, s25
    v_mfma_f32_16x16x32_bf16 v[36:39], v[116:119], v[136:139], v[36:39]
    s_add_u32 m0, s24, 126976
    ds_read_b128 v[80:83], v30 offset:0
    v_mfma_f32_16x16x32_bf16 v[40:43], v[120:123], v[136:139], v[40:43]
    buffer_load_dwordx4 v28, s[8:11], s39 offen lds
    ds_read_b128 v[84:87], v30 offset:1024
    v_mfma_f32_16x16x32_bf16 v[44:47], v[124:127], v[136:139], v[44:47]
    s_add_u32 s39, s36, s25
    ds_read_b128 v[88:91], v30 offset:2048
    v_mfma_f32_16x16x32_bf16 v[48:51], v[128:131], v[136:139], v[48:51]
    s_add_u32 m0, s24, 131072
    ds_read_b128 v[92:95], v30 offset:3072
    v_mfma_f32_16x16x32_bf16 v[52:55], v[132:135], v[136:139], v[52:55]
    buffer_load_dwordx4 v28, s[8:11], s39 offen lds
    ds_read_b128 v[96:99], v30 offset:4096
    v_mfma_f32_16x16x32_bf16 v[56:59], v[112:115], v[140:143], v[56:59]
    s_add_u32 s39, s37, s25
    ds_read_b128 v[100:103], v30 offset:5120
    v_mfma_f32_16x16x32_bf16 v[60:63], v[116:119], v[140:143], v[60:63]
    s_add_u32 m0, s24, 135168
    ds_read_b128 v[104:107], v145 offset:6144
    v_mfma_f32_16x16x32_bf16 v[64:67], v[120:123], v[140:143], v[64:67]
    buffer_load_dwordx4 v28, s[8:11], s39 offen lds
    ds_read_b128 v[108:111], v145 offset:7168
    v_mfma_f32_16x16x32_bf16 v[68:71], v[124:127], v[140:143], v[68:71]
    s_add_u32 s39, s38, s25
    v_mfma_f32_16x16x32_bf16 v[72:75], v[128:131], v[140:143], v[72:75]
    s_add_u32 m0, s24, 139264
    v_mfma_f32_16x16x32_bf16 v[76:79], v[132:135], v[140:143], v[76:79]
    buffer_load_dwordx4 v28, s[8:11], s39 offen lds
    s_waitcnt vmcnt(7)
    s_barrier
    s_waitcnt lgkmcnt(0)
    v_mfma_f32_16x16x32_bf16 v[32:35], v[80:83], v[104:107], v[32:35]
    s_add_u32 s25, s29, 5
    v_mfma_f32_16x16x32_bf16 v[36:39], v[84:87], v[104:107], v[36:39]
    s_and_b32 s25, s25, 7
    ds_read_b128 v[112:115], v30 offset:14336
    v_mfma_f32_16x16x32_bf16 v[40:43], v[88:91], v[104:107], v[40:43]
    s_lshl_b32 s25, s25, 11
    ds_read_b128 v[116:119], v30 offset:15360
    v_mfma_f32_16x16x32_bf16 v[44:47], v[92:95], v[104:107], v[44:47]
    s_add_u32 s39, s32, s25
    ds_read_b128 v[120:123], v30 offset:16384
    v_mfma_f32_16x16x32_bf16 v[48:51], v[96:99], v[104:107], v[48:51]
    s_add_u32 m0, s24, 0
    ds_read_b128 v[124:127], v30 offset:17408
    v_mfma_f32_16x16x32_bf16 v[52:55], v[100:103], v[104:107], v[52:55]
    buffer_load_dwordx4 v28, s[8:11], s39 offen lds
    ds_read_b128 v[128:131], v30 offset:18432
    v_mfma_f32_16x16x32_bf16 v[56:59], v[80:83], v[108:111], v[56:59]
    s_add_u32 s39, s33, s25
    ds_read_b128 v[132:135], v30 offset:19456
    v_mfma_f32_16x16x32_bf16 v[60:63], v[84:87], v[108:111], v[60:63]
    s_add_u32 m0, s24, 4096
    ds_read_b128 v[136:139], v145 offset:20480
    v_mfma_f32_16x16x32_bf16 v[64:67], v[88:91], v[108:111], v[64:67]
    buffer_load_dwordx4 v28, s[8:11], s39 offen lds
    ds_read_b128 v[140:143], v145 offset:21504
    v_mfma_f32_16x16x32_bf16 v[68:71], v[92:95], v[108:111], v[68:71]
    s_add_u32 s39, s34, s25
    v_mfma_f32_16x16x32_bf16 v[72:75], v[96:99], v[108:111], v[72:75]
    s_add_u32 m0, s24, 8192
    v_mfma_f32_16x16x32_bf16 v[76:79], v[100:103], v[108:111], v[76:79]
    buffer_load_dwordx4 v28, s[8:11], s39 offen lds
    s_waitcnt lgkmcnt(0)
    v_mfma_f32_16x16x32_bf16 v[32:35], v[112:115], v[136:139], v[32:35]
    s_add_u32 s39, s35, s25
    v_mfma_f32_16x16x32_bf16 v[36:39], v[116:119], v[136:139], v[36:39]
    s_add_u32 m0, s24, 12288
    ds_read_b128 v[80:83], v30 offset:28672
    v_mfma_f32_16x16x32_bf16 v[40:43], v[120:123], v[136:139], v[40:43]
    buffer_load_dwordx4 v28, s[8:11], s39 offen lds
    ds_read_b128 v[84:87], v30 offset:29696
    v_mfma_f32_16x16x32_bf16 v[44:47], v[124:127], v[136:139], v[44:47]
    s_add_u32 s39, s36, s25
    ds_read_b128 v[88:91], v30 offset:30720
    v_mfma_f32_16x16x32_bf16 v[48:51], v[128:131], v[136:139], v[48:51]
    s_add_u32 m0, s24, 16384
    ds_read_b128 v[92:95], v30 offset:31744
    v_mfma_f32_16x16x32_bf16 v[52:55], v[132:135], v[136:139], v[52:55]
    buffer_load_dwordx4 v28, s[8:11], s39 offen lds
    ds_read_b128 v[96:99], v30 offset:32768
    v_mfma_f32_16x16x32_bf16 v[56:59], v[112:115], v[140:143], v[56:59]
    s_add_u32 s39, s37, s25
    ds_read_b128 v[100:103], v30 offset:33792
    v_mfma_f32_16x16x32_bf16 v[60:63], v[116:119], v[140:143], v[60:63]
    s_add_u32 m0, s24, 20480
    ds_read_b128 v[104:107], v145 offset:34816
    v_mfma_f32_16x16x32_bf16 v[64:67], v[120:123], v[140:143], v[64:67]
    buffer_load_dwordx4 v28, s[8:11], s39 offen lds
    ds_read_b128 v[108:111], v145 offset:35840
    v_mfma_f32_16x16x32_bf16 v[68:71], v[124:127], v[140:143], v[68:71]
    s_add_u32 s39, s38, s25
    v_mfma_f32_16x16x32_bf16 v[72:75], v[128:131], v[140:143], v[72:75]
    s_add_u32 m0, s24, 24576
    v_mfma_f32_16x16x32_bf16 v[76:79], v[132:135], v[140:143], v[76:79]
    buffer_load_dwordx4 v28, s[8:11], s39 offen lds
    s_waitcnt vmcnt(7)
    s_barrier
    s_waitcnt lgkmcnt(0)
    v_mfma_f32_16x16x32_bf16 v[32:35], v[80:83], v[104:107], v[32:35]
    s_add_u32 s25, s29, 6
    v_mfma_f32_16x16x32_bf16 v[36:39], v[84:87], v[104:107], v[36:39]
    s_and_b32 s25, s25, 7
    ds_read_b128 v[112:115], v30 offset:43008
    v_mfma_f32_16x16x32_bf16 v[40:43], v[88:91], v[104:107], v[40:43]
    s_lshl_b32 s25, s25, 11
    ds_read_b128 v[116:119], v30 offset:44032
    v_mfma_f32_16x16x32_bf16 v[44:47], v[92:95], v[104:107], v[44:47]
    s_add_u32 s39, s32, s25
    ds_read_b128 v[120:123], v30 offset:45056
    v_mfma_f32_16x16x32_bf16 v[48:51], v[96:99], v[104:107], v[48:51]
    s_add_u32 m0, s24, 28672
    ds_read_b128 v[124:127], v30 offset:46080
    v_mfma_f32_16x16x32_bf16 v[52:55], v[100:103], v[104:107], v[52:55]
    buffer_load_dwordx4 v28, s[8:11], s39 offen lds
    ds_read_b128 v[128:131], v30 offset:47104
    v_mfma_f32_16x16x32_bf16 v[56:59], v[80:83], v[108:111], v[56:59]
    s_add_u32 s39, s33, s25
    ds_read_b128 v[132:135], v30 offset:48128
    v_mfma_f32_16x16x32_bf16 v[60:63], v[84:87], v[108:111], v[60:63]
    s_add_u32 m0, s24, 32768
    ds_read_b128 v[136:139], v145 offset:49152
    v_mfma_f32_16x16x32_bf16 v[64:67], v[88:91], v[108:111], v[64:67]
    buffer_load_dwordx4 v28, s[8:11], s39 offen lds
    ds_read_b128 v[140:143], v145 offset:50176
    v_mfma_f32_16x16x32_bf16 v[68:71], v[92:95], v[108:111], v[68:71]
    s_add_u32 s39, s34, s25
    v_mfma_f32_16x16x32_bf16 v[72:75], v[96:99], v[108:111], v[72:75]
    s_add_u32 m0, s24, 36864
    v_mfma_f32_16x16x32_bf16 v[76:79], v[100:103], v[108:111], v[76:79]
    buffer_load_dwordx4 v28, s[8:11], s39 offen lds
    s_waitcnt lgkmcnt(0)
    v_mfma_f32_16x16x32_bf16 v[32:35], v[112:115], v[136:139], v[32:35]
    s_add_u32 s39, s35, s25
    v_mfma_f32_16x16x32_bf16 v[36:39], v[116:119], v[136:139], v[36:39]
    s_add_u32 m0, s24, 40960
    ds_read_b128 v[80:83], v31 offset:0
    v_mfma_f32_16x16x32_bf16 v[40:43], v[120:123], v[136:139], v[40:43]
    buffer_load_dwordx4 v28, s[8:11], s39 offen lds
    ds_read_b128 v[84:87], v31 offset:1024
    v_mfma_f32_16x16x32_bf16 v[44:47], v[124:127], v[136:139], v[44:47]
    s_add_u32 s39, s36, s25
    ds_read_b128 v[88:91], v31 offset:2048
    v_mfma_f32_16x16x32_bf16 v[48:51], v[128:131], v[136:139], v[48:51]
    s_add_u32 m0, s24, 45056
    ds_read_b128 v[92:95], v31 offset:3072
    v_mfma_f32_16x16x32_bf16 v[52:55], v[132:135], v[136:139], v[52:55]
    buffer_load_dwordx4 v28, s[8:11], s39 offen lds
    ds_read_b128 v[96:99], v31 offset:4096
    v_mfma_f32_16x16x32_bf16 v[56:59], v[112:115], v[140:143], v[56:59]
    s_add_u32 s39, s37, s25
    ds_read_b128 v[100:103], v31 offset:5120
    v_mfma_f32_16x16x32_bf16 v[60:63], v[116:119], v[140:143], v[60:63]
    s_add_u32 m0, s24, 49152
    ds_read_b128 v[104:107], v146 offset:6144
    v_mfma_f32_16x16x32_bf16 v[64:67], v[120:123], v[140:143], v[64:67]
    buffer_load_dwordx4 v28, s[8:11], s39 offen lds
    ds_read_b128 v[108:111], v146 offset:7168
    v_mfma_f32_16x16x32_bf16 v[68:71], v[124:127], v[140:143], v[68:71]
    s_add_u32 s39, s38, s25
    v_mfma_f32_16x16x32_bf16 v[72:75], v[128:131], v[140:143], v[72:75]
    s_add_u32 m0, s24, 53248
    v_mfma_f32_16x16x32_bf16 v[76:79], v[132:135], v[140:143], v[76:79]
    buffer_load_dwordx4 v28, s[8:11], s39 offen lds
    s_waitcnt vmcnt(7)
    s_barrier
    s_waitcnt lgkmcnt(0)
    v_mfma_f32_16x16x32_bf16 v[32:35], v[80:83], v[104:107], v[32:35]
    s_add_u32 s25, s29, 7
    v_mfma_f32_16x16x32_bf16 v[36:39], v[84:87], v[104:107], v[36:39]
    s_and_b32 s25, s25, 7
    ds_read_b128 v[112:115], v31 offset:14336
    v_mfma_f32_16x16x32_bf16 v[40:43], v[88:91], v[104:107], v[40:43]
    s_lshl_b32 s25, s25, 11
    ds_read_b128 v[116:119], v31 offset:15360
    v_mfma_f32_16x16x32_bf16 v[44:47], v[92:95], v[104:107], v[44:47]
    s_add_u32 s39, s32, s25
    ds_read_b128 v[120:123], v31 offset:16384
    v_mfma_f32_16x16x32_bf16 v[48:51], v[96:99], v[104:107], v[48:51]
    s_add_u32 m0, s24, 57344
    ds_read_b128 v[124:127], v31 offset:17408
    v_mfma_f32_16x16x32_bf16 v[52:55], v[100:103], v[104:107], v[52:55]
    buffer_load_dwordx4 v28, s[8:11], s39 offen lds
    ds_read_b128 v[128:131], v31 offset:18432
    v_mfma_f32_16x16x32_bf16 v[56:59], v[80:83], v[108:111], v[56:59]
    s_add_u32 s39, s33, s25
    ds_read_b128 v[132:135], v31 offset:19456
    v_mfma_f32_16x16x32_bf16 v[60:63], v[84:87], v[108:111], v[60:63]
    s_add_u32 m0, s24, 61440
    ds_read_b128 v[136:139], v146 offset:20480
    v_mfma_f32_16x16x32_bf16 v[64:67], v[88:91], v[108:111], v[64:67]
    buffer_load_dwordx4 v28, s[8:11], s39 offen lds
    ds_read_b128 v[140:143], v146 offset:21504
    v_mfma_f32_16x16x32_bf16 v[68:71], v[92:95], v[108:111], v[68:71]
    s_add_u32 s39, s34, s25
    v_mfma_f32_16x16x32_bf16 v[72:75], v[96:99], v[108:111], v[72:75]
    s_add_u32 m0, s24, 65536
    v_mfma_f32_16x16x32_bf16 v[76:79], v[100:103], v[108:111], v[76:79]
    buffer_load_dwordx4 v28, s[8:11], s39 offen lds
    s_waitcnt lgkmcnt(0)
    v_mfma_f32_16x16x32_bf16 v[32:35], v[112:115], v[136:139], v[32:35]
    s_add_u32 s39, s35, s25
    v_mfma_f32_16x16x32_bf16 v[36:39], v[116:119], v[136:139], v[36:39]
    s_add_u32 m0, s24, 69632
    ds_read_b128 v[80:83], v29 offset:0
    v_mfma_f32_16x16x32_bf16 v[40:43], v[120:123], v[136:139], v[40:43]
    buffer_load_dwordx4 v28, s[8:11], s39 offen lds
    ds_read_b128 v[84:87], v29 offset:1024
    v_mfma_f32_16x16x32_bf16 v[44:47], v[124:127], v[136:139], v[44:47]
    s_add_u32 s39, s36, s25
    ds_read_b128 v[88:91], v29 offset:2048
    v_mfma_f32_16x16x32_bf16 v[48:51], v[128:131], v[136:139], v[48:51]
    s_add_u32 m0, s24, 73728
    ds_read_b128 v[92:95], v29 offset:3072
    v_mfma_f32_16x16x32_bf16 v[52:55], v[132:135], v[136:139], v[52:55]
    buffer_load_dwordx4 v28, s[8:11], s39 offen lds
    ds_read_b128 v[96:99], v29 offset:4096
    v_mfma_f32_16x16x32_bf16 v[56:59], v[112:115], v[140:143], v[56:59]
    s_add_u32 s39, s37, s25
    ds_read_b128 v[100:103], v29 offset:5120
    v_mfma_f32_16x16x32_bf16 v[60:63], v[116:119], v[140:143], v[60:63]
    s_add_u32 m0, s24, 77824
    ds_read_b128 v[104:107], v144 offset:6144
    v_mfma_f32_16x16x32_bf16 v[64:67], v[120:123], v[140:143], v[64:67]
    buffer_load_dwordx4 v28, s[8:11], s39 offen lds
    ds_read_b128 v[108:111], v144 offset:7168
    v_mfma_f32_16x16x32_bf16 v[68:71], v[124:127], v[140:143], v[68:71]
    s_add_u32 s39, s38, s25
    v_mfma_f32_16x16x32_bf16 v[72:75], v[128:131], v[140:143], v[72:75]
    s_add_u32 m0, s24, 81920
    v_mfma_f32_16x16x32_bf16 v[76:79], v[132:135], v[140:143], v[76:79]
    buffer_load_dwordx4 v28, s[8:11], s39 offen lds
    s_waitcnt vmcnt(7)
    s_barrier
    s_waitcnt lgkmcnt(0)
    v_mfma_f32_16x16x32_bf16 v[32:35], v[80:83], v[104:107], v[32:35]
    v_mfma_f32_16x16x32_bf16 v[36:39], v[84:87], v[104:107], v[36:39]
    ds_read_b128 v[112:115], v29 offset:14336
    v_mfma_f32_16x16x32_bf16 v[40:43], v[88:91], v[104:107], v[40:43]
    ds_read_b128 v[116:119], v29 offset:15360
    v_mfma_f32_16x16x32_bf16 v[44:47], v[92:95], v[104:107], v[44:47]
    ds_read_b128 v[120:123], v29 offset:16384
    v_mfma_f32_16x16x32_bf16 v[48:51], v[96:99], v[104:107], v[48:51]
    ds_read_b128 v[124:127], v29 offset:17408
    v_mfma_f32_16x16x32_bf16 v[52:55], v[100:103], v[104:107], v[52:55]
    ds_read_b128 v[128:131], v29 offset:18432
    v_mfma_f32_16x16x32_bf16 v[56:59], v[80:83], v[108:111], v[56:59]
    ds_read_b128 v[132:135], v29 offset:19456
    v_mfma_f32_16x16x32_bf16 v[60:63], v[84:87], v[108:111], v[60:63]
    ds_read_b128 v[136:139], v144 offset:20480
    v_mfma_f32_16x16x32_bf16 v[64:67], v[88:91], v[108:111], v[64:67]
    ds_read_b128 v[140:143], v144 offset:21504
    v_mfma_f32_16x16x32_bf16 v[68:71], v[92:95], v[108:111], v[68:71]
    v_mfma_f32_16x16x32_bf16 v[72:75], v[96:99], v[108:111], v[72:75]
    v_mfma_f32_16x16x32_bf16 v[76:79], v[100:103], v[108:111], v[76:79]
    s_waitcnt lgkmcnt(0)
    v_mfma_f32_16x16x32_bf16 v[32:35], v[112:115], v[136:139], v[32:35]
    v_mfma_f32_16x16x32_bf16 v[36:39], v[116:119], v[136:139], v[36:39]
    ds_read_b128 v[80:83], v29 offset:28672
    v_mfma_f32_16x16x32_bf16 v[40:43], v[120:123], v[136:139], v[40:43]
    ds_read_b128 v[84:87], v29 offset:29696
    v_mfma_f32_16x16x32_bf16 v[44:47], v[124:127], v[136:139], v[44:47]
    ds_read_b128 v[88:91], v29 offset:30720
    v_mfma_f32_16x16x32_bf16 v[48:51], v[128:131], v[136:139], v[48:51]
    ds_read_b128 v[92:95], v29 offset:31744
    v_mfma_f32_16x16x32_bf16 v[52:55], v[132:135], v[136:139], v[52:55]
    ds_read_b128 v[96:99], v29 offset:32768
    v_mfma_f32_16x16x32_bf16 v[56:59], v[112:115], v[140:143], v[56:59]
    ds_read_b128 v[100:103], v29 offset:33792
    v_mfma_f32_16x16x32_bf16 v[60:63], v[116:119], v[140:143], v[60:63]
    ds_read_b128 v[104:107], v144 offset:34816
    v_mfma_f32_16x16x32_bf16 v[64:67], v[120:123], v[140:143], v[64:67]
    ds_read_b128 v[108:111], v144 offset:35840
    v_mfma_f32_16x16x32_bf16 v[68:71], v[124:127], v[140:143], v[68:71]
    v_mfma_f32_16x16x32_bf16 v[72:75], v[128:131], v[140:143], v[72:75]
    v_mfma_f32_16x16x32_bf16 v[76:79], v[132:135], v[140:143], v[76:79]
    s_waitcnt vmcnt(0)
    s_barrier
    s_waitcnt lgkmcnt(0)
    v_mfma_f32_16x16x32_bf16 v[32:35], v[80:83], v[104:107], v[32:35]
    v_mfma_f32_16x16x32_bf16 v[36:39], v[84:87], v[104:107], v[36:39]
    ds_read_b128 v[112:115], v29 offset:43008
    v_mfma_f32_16x16x32_bf16 v[40:43], v[88:91], v[104:107], v[40:43]
    ds_read_b128 v[116:119], v29 offset:44032
    v_mfma_f32_16x16x32_bf16 v[44:47], v[92:95], v[104:107], v[44:47]
    ds_read_b128 v[120:123], v29 offset:45056
    v_mfma_f32_16x16x32_bf16 v[48:51], v[96:99], v[104:107], v[48:51]
    ds_read_b128 v[124:127], v29 offset:46080
    v_mfma_f32_16x16x32_bf16 v[52:55], v[100:103], v[104:107], v[52:55]
    ds_read_b128 v[128:131], v29 offset:47104
    v_mfma_f32_16x16x32_bf16 v[56:59], v[80:83], v[108:111], v[56:59]
    ds_read_b128 v[132:135], v29 offset:48128
    v_mfma_f32_16x16x32_bf16 v[60:63], v[84:87], v[108:111], v[60:63]
    ds_read_b128 v[136:139], v144 offset:49152
    v_mfma_f32_16x16x32_bf16 v[64:67], v[88:91], v[108:111], v[64:67]
    ds_read_b128 v[140:143], v144 offset:50176
    v_mfma_f32_16x16x32_bf16 v[68:71], v[92:95], v[108:111], v[68:71]
    v_mfma_f32_16x16x32_bf16 v[72:75], v[96:99], v[108:111], v[72:75]
    v_mfma_f32_16x16x32_bf16 v[76:79], v[100:103], v[108:111], v[76:79]
    s_waitcnt lgkmcnt(0)
    v_mfma_f32_16x16x32_bf16 v[32:35], v[112:115], v[136:139], v[32:35]
    v_mfma_f32_16x16x32_bf16 v[36:39], v[116:119], v[136:139], v[36:39]
    ds_read_b128 v[80:83], v30 offset:0
    v_mfma_f32_16x16x32_bf16 v[40:43], v[120:123], v[136:139], v[40:43]
    ds_read_b128 v[84:87], v30 offset:1024
    v_mfma_f32_16x16x32_bf16 v[44:47], v[124:127], v[136:139], v[44:47]
    ds_read_b128 v[88:91], v30 offset:2048
    v_mfma_f32_16x16x32_bf16 v[48:51], v[128:131], v[136:139], v[48:51]
    ds_read_b128 v[92:95], v30 offset:3072
    v_mfma_f32_16x16x32_bf16 v[52:55], v[132:135], v[136:139], v[52:55]
    ds_read_b128 v[96:99], v30 offset:4096
    v_mfma_f32_16x16x32_bf16 v[56:59], v[112:115], v[140:143], v[56:59]
    ds_read_b128 v[100:103], v30 offset:5120
    v_mfma_f32_16x16x32_bf16 v[60:63], v[116:119], v[140:143], v[60:63]
    ds_read_b128 v[104:107], v145 offset:6144
    v_mfma_f32_16x16x32_bf16 v[64:67], v[120:123], v[140:143], v[64:67]
    ds_read_b128 v[108:111], v145 offset:7168
    v_mfma_f32_16x16x32_bf16 v[68:71], v[124:127], v[140:143], v[68:71]
    v_mfma_f32_16x16x32_bf16 v[72:75], v[128:131], v[140:143], v[72:75]
    v_mfma_f32_16x16x32_bf16 v[76:79], v[132:135], v[140:143], v[76:79]
    s_waitcnt vmcnt(0)
    s_barrier
    s_waitcnt lgkmcnt(0)
    v_mfma_f32_16x16x32_bf16 v[32:35], v[80:83], v[104:107], v[32:35]
    v_mfma_f32_16x16x32_bf16 v[36:39], v[84:87], v[104:107], v[36:39]
    ds_read_b128 v[112:115], v30 offset:14336
    v_mfma_f32_16x16x32_bf16 v[40:43], v[88:91], v[104:107], v[40:43]
    ds_read_b128 v[116:119], v30 offset:15360
    v_mfma_f32_16x16x32_bf16 v[44:47], v[92:95], v[104:107], v[44:47]
    ds_read_b128 v[120:123], v30 offset:16384
    v_mfma_f32_16x16x32_bf16 v[48:51], v[96:99], v[104:107], v[48:51]
    ds_read_b128 v[124:127], v30 offset:17408
    v_mfma_f32_16x16x32_bf16 v[52:55], v[100:103], v[104:107], v[52:55]
    ds_read_b128 v[128:131], v30 offset:18432
    v_mfma_f32_16x16x32_bf16 v[56:59], v[80:83], v[108:111], v[56:59]
    ds_read_b128 v[132:135], v30 offset:19456
    v_mfma_f32_16x16x32_bf16 v[60:63], v[84:87], v[108:111], v[60:63]
    ds_read_b128 v[136:139], v145 offset:20480
    v_mfma_f32_16x16x32_bf16 v[64:67], v[88:91], v[108:111], v[64:67]
    ds_read_b128 v[140:143], v145 offset:21504
    v_mfma_f32_16x16x32_bf16 v[68:71], v[92:95], v[108:111], v[68:71]
    v_mfma_f32_16x16x32_bf16 v[72:75], v[96:99], v[108:111], v[72:75]
    v_mfma_f32_16x16x32_bf16 v[76:79], v[100:103], v[108:111], v[76:79]
    s_waitcnt lgkmcnt(0)
    v_mfma_f32_16x16x32_bf16 v[32:35], v[112:115], v[136:139], v[32:35]
    v_mfma_f32_16x16x32_bf16 v[36:39], v[116:119], v[136:139], v[36:39]
    v_mfma_f32_16x16x32_bf16 v[40:43], v[120:123], v[136:139], v[40:43]
    v_mfma_f32_16x16x32_bf16 v[44:47], v[124:127], v[136:139], v[44:47]
    v_mfma_f32_16x16x32_bf16 v[48:51], v[128:131], v[136:139], v[48:51]
    v_mfma_f32_16x16x32_bf16 v[52:55], v[132:135], v[136:139], v[52:55]
    v_mfma_f32_16x16x32_bf16 v[56:59], v[112:115], v[140:143], v[56:59]
    v_mfma_f32_16x16x32_bf16 v[60:63], v[116:119], v[140:143], v[60:63]
    v_mfma_f32_16x16x32_bf16 v[64:67], v[120:123], v[140:143], v[64:67]
    v_mfma_f32_16x16x32_bf16 v[68:71], v[124:127], v[140:143], v[68:71]
    v_mfma_f32_16x16x32_bf16 v[72:75], v[128:131], v[140:143], v[72:75]
    v_mfma_f32_16x16x32_bf16 v[76:79], v[132:135], v[140:143], v[76:79]
    s_nop 15
    s_nop 7
    s_mov_b32 s27, 0x40135761
    s_mov_b32 s28, 0x3dd2d3e7
    v_mov_b32 v116, s28
    v_mov_b32 v117, s28
    v_mov_b32 v118, s27
    v_mov_b32 v119, s27
    v_mov_b32 v120, 1.0
    v_mov_b32 v121, 1.0
    s_lshr_b32 s23, s20, 4
    s_lshl_b32 s29, s22, 1
    s_add_u32 s23, s23, s29
    s_mul_i32 s23, s23, 43
    s_lshr_b32 s29, s2, 4
    s_mul_i32 s29, s29, 3
    s_add_u32 s23, s23, s29
    s_lshl_b32 s23, s23, 10
    s_add_u32 s23, s23, 12582912
    v_add_u32 v7, s23, v28
    v_add_u32 v8, 44032, v7
    v_lshlrev_b32 v80, 16, v16
    v_and_b32 v81, 0xffff0000, v16
    v_lshlrev_b32 v82, 16, v17
    v_and_b32 v83, 0xffff0000, v17
    v_lshlrev_b32 v84, 16, v18
    v_and_b32 v85, 0xffff0000, v18
    v_lshlrev_b32 v86, 16, v19
    v_and_b32 v87, 0xffff0000, v19
    v_cvt_pk_bf16_f32 v96, v32, v33
    v_cvt_pk_bf16_f32 v97, v34, v35
    v_cvt_pk_bf16_f32 v98, v36, v37
    v_cvt_pk_bf16_f32 v99, v38, v39
    v_lshlrev_b32 v88, 16, v96
    v_and_b32 v89, 0xffff0000, v96
    v_lshlrev_b32 v90, 16, v97
    v_and_b32 v91, 0xffff0000, v97
    v_lshlrev_b32 v92, 16, v98
    v_and_b32 v93, 0xffff0000, v98
    v_lshlrev_b32 v94, 16, v99
    v_and_b32 v95, 0xffff0000, v99
    v_pk_add_f32 v[88:89], v[88:89], v[80:81]
    v_pk_add_f32 v[90:91], v[90:91], v[82:83]
    v_pk_add_f32 v[92:93], v[92:93], v[84:85]
    v_pk_add_f32 v[94:95], v[94:95], v[86:87]
    v_cvt_pk_bf16_f32 v96, v88, v89
    v_cvt_pk_bf16_f32 v97, v90, v91
    v_cvt_pk_bf16_f32 v98, v92, v93
    v_cvt_pk_bf16_f32 v99, v94, v95
    v_lshlrev_b32 v88, 16, v96
    v_and_b32 v89, 0xffff0000, v96
    v_lshlrev_b32 v90, 16, v97
    v_and_b32 v91, 0xffff0000, v97
    v_lshlrev_b32 v92, 16, v98
    v_and_b32 v93, 0xffff0000, v98
    v_lshlrev_b32 v94, 16, v99
    v_and_b32 v95, 0xffff0000, v99
    v_pk_mul_f32 v[100:101], v[88:89], v[88:89]
    v_pk_mul_f32 v[102:103], v[90:91], v[90:91]
    v_pk_mul_f32 v[104:105], v[92:93], v[92:93]
    v_pk_mul_f32 v[106:107], v[94:95], v[94:95]
    v_pk_fma_f32 v[100:101], v[100:101], v[116:117], v[118:119]
    v_pk_fma_f32 v[102:103], v[102:103], v[116:117], v[118:119]
    v_pk_fma_f32 v[104:105], v[104:105], v[116:117], v[118:119]
    v_pk_fma_f32 v[106:107], v[106:107], v[116:117], v[118:119]
    v_pk_mul_f32 v[100:101], v[100:101], v[88:89]
    v_pk_mul_f32 v[102:103], v[102:103], v[90:91]
    v_pk_mul_f32 v[104:105], v[104:105], v[92:93]
    v_pk_mul_f32 v[106:107], v[106:107], v[94:95]
    v_exp_f32 v100, -v100
    v_exp_f32 v101, -v101
    v_exp_f32 v102, -v102
    v_exp_f32 v103, -v103
    v_exp_f32 v104, -v104
    v_exp_f32 v105, -v105
    v_exp_f32 v106, -v106
    v_exp_f32 v107, -v107
    v_pk_add_f32 v[100:101], v[100:101], v[120:121]
    s_nop 0
    v_pk_add_f32 v[102:103], v[102:103], v[120:121]
    s_nop 0
    v_pk_add_f32 v[104:105], v[104:105], v[120:121]
    s_nop 0
    v_pk_add_f32 v[106:107], v[106:107], v[120:121]
    v_rcp_f32 v100, v100
    v_rcp_f32 v101, v101
    v_rcp_f32 v102, v102
    v_rcp_f32 v103, v103
    v_rcp_f32 v104, v104
    v_rcp_f32 v105, v105
    v_rcp_f32 v106, v106
    v_rcp_f32 v107, v107
    v_pk_mul_f32 v[100:101], v[100:101], v[88:89]
    s_nop 0
    v_pk_mul_f32 v[102:103], v[102:103], v[90:91]
    s_nop 0
    v_pk_mul_f32 v[104:105], v[104:105], v[92:93]
    s_nop 0
    v_pk_mul_f32 v[106:107], v[106:107], v[94:95]
    v_cvt_pk_bf16_f32 v108, v100, v101
    v_cvt_pk_bf16_f32 v109, v102, v103
    v_cvt_pk_bf16_f32 v110, v104, v105
    v_cvt_pk_bf16_f32 v111, v106, v107
    buffer_store_dwordx4 v[108:111], v7, s[8:11], 0 offen offset:0
    v_cvt_pk_bf16_f32 v96, v56, v57
    v_cvt_pk_bf16_f32 v97, v58, v59
    v_cvt_pk_bf16_f32 v98, v60, v61
    v_cvt_pk_bf16_f32 v99, v62, v63
    v_lshlrev_b32 v88, 16, v96
    v_and_b32 v89, 0xffff0000, v96
    v_lshlrev_b32 v90, 16, v97
    v_and_b32 v91, 0xffff0000, v97
    v_lshlrev_b32 v92, 16, v98
    v_and_b32 v93, 0xffff0000, v98
    v_lshlrev_b32 v94, 16, v99
    v_and_b32 v95, 0xffff0000, v99
    v_pk_add_f32 v[88:89], v[88:89], v[80:81]
    v_pk_add_f32 v[90:91], v[90:91], v[82:83]
    v_pk_add_f32 v[92:93], v[92:93], v[84:85]
    v_pk_add_f32 v[94:95], v[94:95], v[86:87]
    v_cvt_pk_bf16_f32 v96, v88, v89
    v_cvt_pk_bf16_f32 v97, v90, v91
    v_cvt_pk_bf16_f32 v98, v92, v93
    v_cvt_pk_bf16_f32 v99, v94, v95
    v_lshlrev_b32 v88, 16, v96
    v_and_b32 v89, 0xffff0000, v96
    v_lshlrev_b32 v90, 16, v97
    v_and_b32 v91, 0xffff0000, v97
    v_lshlrev_b32 v92, 16, v98
    v_and_b32 v93, 0xffff0000, v98
    v_lshlrev_b32 v94, 16, v99
    v_and_b32 v95, 0xffff0000, v99
    v_pk_mul_f32 v[100:101], v[88:89], v[88:89]
    v_pk_mul_f32 v[102:103], v[90:91], v[90:91]
    v_pk_mul_f32 v[104:105], v[92:93], v[92:93]
    v_pk_mul_f32 v[106:107], v[94:95], v[94:95]
    v_pk_fma_f32 v[100:101], v[100:101], v[116:117], v[118:119]
    v_pk_fma_f32 v[102:103], v[102:103], v[116:117], v[118:119]
    v_pk_fma_f32 v[104:105], v[104:105], v[116:117], v[118:119]
    v_pk_fma_f32 v[106:107], v[106:107], v[116:117], v[118:119]
    v_pk_mul_f32 v[100:101], v[100:101], v[88:89]
    v_pk_mul_f32 v[102:103], v[102:103], v[90:91]
    v_pk_mul_f32 v[104:105], v[104:105], v[92:93]
    v_pk_mul_f32 v[106:107], v[106:107], v[94:95]
    v_exp_f32 v100, -v100
    v_exp_f32 v101, -v101
    v_exp_f32 v102, -v102
    v_exp_f32 v103, -v103
    v_exp_f32 v104, -v104
    v_exp_f32 v105, -v105
    v_exp_f32 v106, -v106
    v_exp_f32 v107, -v107
    v_pk_add_f32 v[100:101], v[100:101], v[120:121]
    s_nop 0
    v_pk_add_f32 v[102:103], v[102:103], v[120:121]
    s_nop 0
    v_pk_add_f32 v[104:105], v[104:105], v[120:121]
    s_nop 0
    v_pk_add_f32 v[106:107], v[106:107], v[120:121]
    v_rcp_f32 v100, v100
    v_rcp_f32 v101, v101
    v_rcp_f32 v102, v102
    v_rcp_f32 v103, v103
    v_rcp_f32 v104, v104
    v_rcp_f32 v105, v105
    v_rcp_f32 v106, v106
    v_rcp_f32 v107, v107
    v_pk_mul_f32 v[100:101], v[100:101], v[88:89]
    s_nop 0
    v_pk_mul_f32 v[102:103], v[102:103], v[90:91]
    s_nop 0
    v_pk_mul_f32 v[104:105], v[104:105], v[92:93]
    s_nop 0
    v_pk_mul_f32 v[106:107], v[106:107], v[94:95]
    v_cvt_pk_bf16_f32 v112, v100, v101
    v_cvt_pk_bf16_f32 v113, v102, v103
    v_cvt_pk_bf16_f32 v114, v104, v105
    v_cvt_pk_bf16_f32 v115, v106, v107
    buffer_store_dwordx4 v[112:115], v8, s[8:11], 0 offen offset:0
    s_add_u32 s23, s21, 32
    s_cmp_ge_u32 s23, 1376
    s_cbranch_scc1 K4_FIN
    v_lshlrev_b32 v80, 16, v20
    v_and_b32 v81, 0xffff0000, v20
    v_lshlrev_b32 v82, 16, v21
    v_and_b32 v83, 0xffff0000, v21
    v_lshlrev_b32 v84, 16, v22
    v_and_b32 v85, 0xffff0000, v22
    v_lshlrev_b32 v86, 16, v23
    v_and_b32 v87, 0xffff0000, v23
    v_cvt_pk_bf16_f32 v96, v40, v41
    v_cvt_pk_bf16_f32 v97, v42, v43
    v_cvt_pk_bf16_f32 v98, v44, v45
    v_cvt_pk_bf16_f32 v99, v46, v47
    v_lshlrev_b32 v88, 16, v96
    v_and_b32 v89, 0xffff0000, v96
    v_lshlrev_b32 v90, 16, v97
    v_and_b32 v91, 0xffff0000, v97
    v_lshlrev_b32 v92, 16, v98
    v_and_b32 v93, 0xffff0000, v98
    v_lshlrev_b32 v94, 16, v99
    v_and_b32 v95, 0xffff0000, v99
    v_pk_add_f32 v[88:89], v[88:89], v[80:81]
    v_pk_add_f32 v[90:91], v[90:91], v[82:83]
    v_pk_add_f32 v[92:93], v[92:93], v[84:85]
    v_pk_add_f32 v[94:95], v[94:95], v[86:87]
    v_cvt_pk_bf16_f32 v96, v88, v89
    v_cvt_pk_bf16_f32 v97, v90, v91
    v_cvt_pk_bf16_f32 v98, v92, v93
    v_cvt_pk_bf16_f32 v99, v94, v95
    v_lshlrev_b32 v88, 16, v96
    v_and_b32 v89, 0xffff0000, v96
    v_lshlrev_b32 v90, 16, v97
    v_and_b32 v91, 0xffff0000, v97
    v_lshlrev_b32 v92, 16, v98
    v_and_b32 v93, 0xffff0000, v98
    v_lshlrev_b32 v94, 16, v99
    v_and_b32 v95, 0xffff0000, v99
    v_pk_mul_f32 v[100:101], v[88:89], v[88:89]
    v_pk_mul_f32 v[102:103], v[90:91], v[90:91]
    v_pk_mul_f32 v[104:105], v[92:93], v[92:93]
    v_pk_mul_f32 v[106:107], v[94:95], v[94:95]
    v_pk_fma_f32 v[100:101], v[100:101], v[116:117], v[118:119]
    v_pk_fma_f32 v[102:103], v[102:103], v[116:117], v[118:119]
    v_pk_fma_f32 v[104:105], v[104:105], v[116:117], v[118:119]
    v_pk_fma_f32 v[106:107], v[106:107], v[116:117], v[118:119]
    v_pk_mul_f32 v[100:101], v[100:101], v[88:89]
    v_pk_mul_f32 v[102:103], v[102:103], v[90:91]
    v_pk_mul_f32 v[104:105], v[104:105], v[92:93]
    v_pk_mul_f32 v[106:107], v[106:107], v[94:95]
    v_exp_f32 v100, -v100
    v_exp_f32 v101, -v101
    v_exp_f32 v102, -v102
    v_exp_f32 v103, -v103
    v_exp_f32 v104, -v104
    v_exp_f32 v105, -v105
    v_exp_f32 v106, -v106
    v_exp_f32 v107, -v107
    v_pk_add_f32 v[100:101], v[100:101], v[120:121]
    s_nop 0
    v_pk_add_f32 v[102:103], v[102:103], v[120:121]
    s_nop 0
    v_pk_add_f32 v[104:105], v[104:105], v[120:121]
    s_nop 0
    v_pk_add_f32 v[106:107], v[106:107], v[120:121]
    v_rcp_f32 v100, v100
    v_rcp_f32 v101, v101
    v_rcp_f32 v102, v102
    v_rcp_f32 v103, v103
    v_rcp_f32 v104, v104
    v_rcp_f32 v105, v105
    v_rcp_f32 v106, v106
    v_rcp_f32 v107, v107
    v_pk_mul_f32 v[100:101], v[100:101], v[88:89]
    s_nop 0
    v_pk_mul_f32 v[102:103], v[102:103], v[90:91]
    s_nop 0
    v_pk_mul_f32 v[104:105], v[104:105], v[92:93]
    s_nop 0
    v_pk_mul_f32 v[106:107], v[106:107], v[94:95]
    v_cvt_pk_bf16_f32 v108, v100, v101
    v_cvt_pk_bf16_f32 v109, v102, v103
    v_cvt_pk_bf16_f32 v110, v104, v105
    v_cvt_pk_bf16_f32 v111, v106, v107
    buffer_store_dwordx4 v[108:111], v7, s[8:11], 0 offen offset:1024
    v_cvt_pk_bf16_f32 v96, v64, v65
    v_cvt_pk_bf16_f32 v97, v66, v67
    v_cvt_pk_bf16_f32 v98, v68, v69
    v_cvt_pk_bf16_f32 v99, v70, v71
    v_lshlrev_b32 v88, 16, v96
    v_and_b32 v89, 0xffff0000, v96
    v_lshlrev_b32 v90, 16, v97
    v_and_b32 v91, 0xffff0000, v97
    v_lshlrev_b32 v92, 16, v98
    v_and_b32 v93, 0xffff0000, v98
    v_lshlrev_b32 v94, 16, v99
    v_and_b32 v95, 0xffff0000, v99
    v_pk_add_f32 v[88:89], v[88:89], v[80:81]
    v_pk_add_f32 v[90:91], v[90:91], v[82:83]
    v_pk_add_f32 v[92:93], v[92:93], v[84:85]
    v_pk_add_f32 v[94:95], v[94:95], v[86:87]
    v_cvt_pk_bf16_f32 v96, v88, v89
    v_cvt_pk_bf16_f32 v97, v90, v91
    v_cvt_pk_bf16_f32 v98, v92, v93
    v_cvt_pk_bf16_f32 v99, v94, v95
    v_lshlrev_b32 v88, 16, v96
    v_and_b32 v89, 0xffff0000, v96
    v_lshlrev_b32 v90, 16, v97
    v_and_b32 v91, 0xffff0000, v97
    v_lshlrev_b32 v92, 16, v98
    v_and_b32 v93, 0xffff0000, v98
    v_lshlrev_b32 v94, 16, v99
    v_and_b32 v95, 0xffff0000, v99
    v_pk_mul_f32 v[100:101], v[88:89], v[88:89]
    v_pk_mul_f32 v[102:103], v[90:91], v[90:91]
    v_pk_mul_f32 v[104:105], v[92:93], v[92:93]
    v_pk_mul_f32 v[106:107], v[94:95], v[94:95]
    v_pk_fma_f32 v[100:101], v[100:101], v[116:117], v[118:119]
    v_pk_fma_f32 v[102:103], v[102:103], v[116:117], v[118:119]
    v_pk_fma_f32 v[104:105], v[104:105], v[116:117], v[118:119]
    v_pk_fma_f32 v[106:107], v[106:107], v[116:117], v[118:119]
    v_pk_mul_f32 v[100:101], v[100:101], v[88:89]
    v_pk_mul_f32 v[102:103], v[102:103], v[90:91]
    v_pk_mul_f32 v[104:105], v[104:105], v[92:93]
    v_pk_mul_f32 v[106:107], v[106:107], v[94:95]
    v_exp_f32 v100, -v100
    v_exp_f32 v101, -v101
    v_exp_f32 v102, -v102
    v_exp_f32 v103, -v103
    v_exp_f32 v104, -v104
    v_exp_f32 v105, -v105
    v_exp_f32 v106, -v106
    v_exp_f32 v107, -v107
    v_pk_add_f32 v[100:101], v[100:101], v[120:121]
    s_nop 0
    v_pk_add_f32 v[102:103], v[102:103], v[120:121]
    s_nop 0
    v_pk_add_f32 v[104:105], v[104:105], v[120:121]
    s_nop 0
    v_pk_add_f32 v[106:107], v[106:107], v[120:121]
    v_rcp_f32 v100, v100
    v_rcp_f32 v101, v101
    v_rcp_f32 v102, v102
    v_rcp_f32 v103, v103
    v_rcp_f32 v104, v104
    v_rcp_f32 v105, v105
    v_rcp_f32 v106, v106
    v_rcp_f32 v107, v107
    v_pk_mul_f32 v[100:101], v[100:101], v[88:89]
    s_nop 0
    v_pk_mul_f32 v[102:103], v[102:103], v[90:91]
    s_nop 0
    v_pk_mul_f32 v[104:105], v[104:105], v[92:93]
    s_nop 0
    v_pk_mul_f32 v[106:107], v[106:107], v[94:95]
    v_cvt_pk_bf16_f32 v112, v100, v101
    v_cvt_pk_bf16_f32 v113, v102, v103
    v_cvt_pk_bf16_f32 v114, v104, v105
    v_cvt_pk_bf16_f32 v115, v106, v107
    buffer_store_dwordx4 v[112:115], v8, s[8:11], 0 offen offset:1024
    s_add_u32 s23, s21, 64
    s_cmp_ge_u32 s23, 1376
    s_cbranch_scc1 K4_FIN
    v_lshlrev_b32 v80, 16, v24
    v_and_b32 v81, 0xffff0000, v24
    v_lshlrev_b32 v82, 16, v25
    v_and_b32 v83, 0xffff0000, v25
    v_lshlrev_b32 v84, 16, v26
    v_and_b32 v85, 0xffff0000, v26
    v_lshlrev_b32 v86, 16, v27
    v_and_b32 v87, 0xffff0000, v27
    v_cvt_pk_bf16_f32 v96, v48, v49
    v_cvt_pk_bf16_f32 v97, v50, v51
    v_cvt_pk_bf16_f32 v98, v52, v53
    v_cvt_pk_bf16_f32 v99, v54, v55
    v_lshlrev_b32 v88, 16, v96
    v_and_b32 v89, 0xffff0000, v96
    v_lshlrev_b32 v90, 16, v97
    v_and_b32 v91, 0xffff0000, v97
    v_lshlrev_b32 v92, 16, v98
    v_and_b32 v93, 0xffff0000, v98
    v_lshlrev_b32 v94, 16, v99
    v_and_b32 v95, 0xffff0000, v99
    v_pk_add_f32 v[88:89], v[88:89], v[80:81]
    v_pk_add_f32 v[90:91], v[90:91], v[82:83]
    v_pk_add_f32 v[92:93], v[92:93], v[84:85]
    v_pk_add_f32 v[94:95], v[94:95], v[86:87]
    v_cvt_pk_bf16_f32 v96, v88, v89
    v_cvt_pk_bf16_f32 v97, v90, v91
    v_cvt_pk_bf16_f32 v98, v92, v93
    v_cvt_pk_bf16_f32 v99, v94, v95
    v_lshlrev_b32 v88, 16, v96
    v_and_b32 v89, 0xffff0000, v96
    v_lshlrev_b32 v90, 16, v97
    v_and_b32 v91, 0xffff0000, v97
    v_lshlrev_b32 v92, 16, v98
    v_and_b32 v93, 0xffff0000, v98
    v_lshlrev_b32 v94, 16, v99
    v_and_b32 v95, 0xffff0000, v99
    v_pk_mul_f32 v[100:101], v[88:89], v[88:89]
    v_pk_mul_f32 v[102:103], v[90:91], v[90:91]
    v_pk_mul_f32 v[104:105], v[92:93], v[92:93]
    v_pk_mul_f32 v[106:107], v[94:95], v[94:95]
    v_pk_fma_f32 v[100:101], v[100:101], v[116:117], v[118:119]
    v_pk_fma_f32 v[102:103], v[102:103], v[116:117], v[118:119]
    v_pk_fma_f32 v[104:105], v[104:105], v[116:117], v[118:119]
    v_pk_fma_f32 v[106:107], v[106:107], v[116:117], v[118:119]
    v_pk_mul_f32 v[100:101], v[100:101], v[88:89]
    v_pk_mul_f32 v[102:103], v[102:103], v[90:91]
    v_pk_mul_f32 v[104:105], v[104:105], v[92:93]
    v_pk_mul_f32 v[106:107], v[106:107], v[94:95]
    v_exp_f32 v100, -v100
    v_exp_f32 v101, -v101
    v_exp_f32 v102, -v102
    v_exp_f32 v103, -v103
    v_exp_f32 v104, -v104
    v_exp_f32 v105, -v105
    v_exp_f32 v106, -v106
    v_exp_f32 v107, -v107
    v_pk_add_f32 v[100:101], v[100:101], v[120:121]
    s_nop 0
    v_pk_add_f32 v[102:103], v[102:103], v[120:121]
    s_nop 0
    v_pk_add_f32 v[104:105], v[104:105], v[120:121]
    s_nop 0
    v_pk_add_f32 v[106:107], v[106:107], v[120:121]
    v_rcp_f32 v100, v100
    v_rcp_f32 v101, v101
    v_rcp_f32 v102, v102
    v_rcp_f32 v103, v103
    v_rcp_f32 v104, v104
    v_rcp_f32 v105, v105
    v_rcp_f32 v106, v106
    v_rcp_f32 v107, v107
    v_pk_mul_f32 v[100:101], v[100:101], v[88:89]
    s_nop 0
    v_pk_mul_f32 v[102:103], v[102:103], v[90:91]
    s_nop 0
    v_pk_mul_f32 v[104:105], v[104:105], v[92:93]
    s_nop 0
    v_pk_mul_f32 v[106:107], v[106:107], v[94:95]
    v_cvt_pk_bf16_f32 v108, v100, v101
    v_cvt_pk_bf16_f32 v109, v102, v103
    v_cvt_pk_bf16_f32 v110, v104, v105
    v_cvt_pk_bf16_f32 v111, v106, v107
    buffer_store_dwordx4 v[108:111], v7, s[8:11], 0 offen offset:2048
    v_cvt_pk_bf16_f32 v96, v72, v73
    v_cvt_pk_bf16_f32 v97, v74, v75
    v_cvt_pk_bf16_f32 v98, v76, v77
    v_cvt_pk_bf16_f32 v99, v78, v79
    v_lshlrev_b32 v88, 16, v96
    v_and_b32 v89, 0xffff0000, v96
    v_lshlrev_b32 v90, 16, v97
    v_and_b32 v91, 0xffff0000, v97
    v_lshlrev_b32 v92, 16, v98
    v_and_b32 v93, 0xffff0000, v98
    v_lshlrev_b32 v94, 16, v99
    v_and_b32 v95, 0xffff0000, v99
    v_pk_add_f32 v[88:89], v[88:89], v[80:81]
    v_pk_add_f32 v[90:91], v[90:91], v[82:83]
    v_pk_add_f32 v[92:93], v[92:93], v[84:85]
    v_pk_add_f32 v[94:95], v[94:95], v[86:87]
    v_cvt_pk_bf16_f32 v96, v88, v89
    v_cvt_pk_bf16_f32 v97, v90, v91
    v_cvt_pk_bf16_f32 v98, v92, v93
    v_cvt_pk_bf16_f32 v99, v94, v95
    v_lshlrev_b32 v88, 16, v96
    v_and_b32 v89, 0xffff0000, v96
    v_lshlrev_b32 v90, 16, v97
    v_and_b32 v91, 0xffff0000, v97
    v_lshlrev_b32 v92, 16, v98
    v_and_b32 v93, 0xffff0000, v98
    v_lshlrev_b32 v94, 16, v99
    v_and_b32 v95, 0xffff0000, v99
    v_pk_mul_f32 v[100:101], v[88:89], v[88:89]
    v_pk_mul_f32 v[102:103], v[90:91], v[90:91]
    v_pk_mul_f32 v[104:105], v[92:93], v[92:93]
    v_pk_mul_f32 v[106:107], v[94:95], v[94:95]
    v_pk_fma_f32 v[100:101], v[100:101], v[116:117], v[118:119]
    v_pk_fma_f32 v[102:103], v[102:103], v[116:117], v[118:119]
    v_pk_fma_f32 v[104:105], v[104:105], v[116:117], v[118:119]
    v_pk_fma_f32 v[106:107], v[106:107], v[116:117], v[118:119]
    v_pk_mul_f32 v[100:101], v[100:101], v[88:89]
    v_pk_mul_f32 v[102:103], v[102:103], v[90:91]
    v_pk_mul_f32 v[104:105], v[104:105], v[92:93]
    v_pk_mul_f32 v[106:107], v[106:107], v[94:95]
    v_exp_f32 v100, -v100
    v_exp_f32 v101, -v101
    v_exp_f32 v102, -v102
    v_exp_f32 v103, -v103
    v_exp_f32 v104, -v104
    v_exp_f32 v105, -v105
    v_exp_f32 v106, -v106
    v_exp_f32 v107, -v107
    v_pk_add_f32 v[100:101], v[100:101], v[120:121]
    s_nop 0
    v_pk_add_f32 v[102:103], v[102:103], v[120:121]
    s_nop 0
    v_pk_add_f32 v[104:105], v[104:105], v[120:121]
    s_nop 0
    v_pk_add_f32 v[106:107], v[106:107], v[120:121]
    v_rcp_f32 v100, v100
    v_rcp_f32 v101, v101
    v_rcp_f32 v102, v102
    v_rcp_f32 v103, v103
    v_rcp_f32 v104, v104
    v_rcp_f32 v105, v105
    v_rcp_f32 v106, v106
    v_rcp_f32 v107, v107
    v_pk_mul_f32 v[100:101], v[100:101], v[88:89]
    s_nop 0
    v_pk_mul_f32 v[102:103], v[102:103], v[90:91]
    s_nop 0
    v_pk_mul_f32 v[104:105], v[104:105], v[92:93]
    s_nop 0
    v_pk_mul_f32 v[106:107], v[106:107], v[94:95]
    v_cvt_pk_bf16_f32 v112, v100, v101
    v_cvt_pk_bf16_f32 v113, v102, v103
    v_cvt_pk_bf16_f32 v114, v104, v105
    v_cvt_pk_bf16_f32 v115, v106, v107
    buffer_store_dwordx4 v[112:115], v8, s[8:11], 0 offen offset:2048
K4_FIN:
K4_END:
    s_endpgm
.globl k5_kernel
.p2align 8
.type k5_kernel,@function
k5_kernel:
    s_cmp_ge_u32 s2, 256
    s_cbranch_scc1 K5_END
    s_load_dwordx2 s[4:5], s[0:1], 112
    s_load_dwordx2 s[6:7], s[0:1], 88
    s_load_dwordx2 s[16:17], s[0:1], 96
    s_and_b32 s20, s2, 7
    s_lshl_b32 s20, s20, 2
    s_bfe_u32 s21, s2, 0x20003
    s_add_u32 s20, s20, s21
    s_lshr_b32 s21, s2, 5
    s_lshl_b32 s20, s20, 6
    s_lshl_b32 s21, s21, 6
    v_lshrrev_b32 v1, 6, v0
    s_nop 0
    v_readfirstlane_b32 s22, v1
    v_and_b32 v2, 63, v0
    v_and_b32 v3, 15, v2
    v_lshrrev_b32 v4, 4, v2
    s_waitcnt lgkmcnt(0)
    s_mov_b32 s8, s4
    s_and_b32 s9, s5, 0xffff
    s_mov_b32 s10, 0x10000000
    s_mov_b32 s11, 0x20000
    s_mov_b32 s12, s6
    s_and_b32 s13, s7, 0xffff
    s_mov_b32 s14, 0x400
    s_mov_b32 s15, 0x20000
    s_mov_b32 s28, s16
    s_and_b32 s29, s17, 0xffff
    s_mov_b32 s30, 0x200000
    s_mov_b32 s31, 0x20000
    v_lshlrev_b32 v17, 4, v2
    s_lshr_b32 s23, s21, 4
    s_mul_i32 s23, s23, 44032
    s_add_u32 s32, s23, 10485760
    s_lshr_b32 s23, s20, 4
    s_mul_i32 s23, s23, 44032
    s_add_u32 s33, s23, 12582912
    s_cmp_eq_u32 s22, 3
    s_cselect_b32 s34, 10, 11
    s_mov_b32 s35, 0
    s_lshl_b32 s36, s35, 2
    s_add_u32 s36, s36, s22
    s_lshl_b32 s36, s36, 10
    s_add_u32 s37, s36, s32
    s_add_u32 s38, s36, s33
    buffer_load_dwordx4 v[96:99], v17, s[8:11], s37 offen
    s_add_u32 s37, s37, 44032
    buffer_load_dwordx4 v[100:103], v17, s[8:11], s37 offen
    s_add_u32 s37, s37, 44032
    buffer_load_dwordx4 v[104:107], v17, s[8:11], s37 offen
    s_add_u32 s37, s37, 44032
    buffer_load_dwordx4 v[108:111], v17, s[8:11], s37 offen
    buffer_load_dwordx4 v[112:115], v17, s[8:11], s38 offen
    s_add_u32 s38, s38, 44032
    buffer_load_dwordx4 v[116:119], v17, s[8:11], s38 offen
    s_add_u32 s38, s38, 44032
    buffer_load_dwordx4 v[120:123], v17, s[8:11], s38 offen
    s_add_u32 s38, s38, 44032
    buffer_load_dwordx4 v[124:127], v17, s[8:11], s38 offen
    s_add_u32 s35, s35, 1
    s_cmp_ge_u32 s35, s34
    s_cselect_b32 s35, 0, s35
    s_lshl_b32 s36, s35, 2
    s_add_u32 s36, s36, s22
    s_lshl_b32 s36, s36, 10
    s_add_u32 s37, s36, s32
    s_add_u32 s38, s36, s33
    buffer_load_dwordx4 v[128:131], v17, s[8:11], s37 offen
    s_add_u32 s37, s37, 44032
    buffer_load_dwordx4 v[132:135], v17, s[8:11], s37 offen
    s_add_u32 s37, s37, 44032
    buffer_load_dwordx4 v[136:139], v17, s[8:11], s37 offen
    s_add_u32 s37, s37, 44032
    buffer_load_dwordx4 v[140:143], v17, s[8:11], s37 offen
    buffer_load_dwordx4 v[144:147], v17, s[8:11], s38 offen
    s_add_u32 s38, s38, 44032
    buffer_load_dwordx4 v[148:151], v17, s[8:11], s38 offen
    s_add_u32 s38, s38, 44032
    buffer_load_dwordx4 v[152:155], v17, s[8:11], s38 offen
    s_add_u32 s38, s38, 44032
    buffer_load_dwordx4 v[156:159], v17, s[8:11], s38 offen
    s_add_u32 s35, s35, 1
    s_cmp_ge_u32 s35, s34
    s_cselect_b32 s35, 0, s35
    s_lshl_b32 s36, s35, 2
    s_add_u32 s36, s36, s22
    s_lshl_b32 s36, s36, 10
    s_add_u32 s37, s36, s32
    s_add_u32 s38, s36, s33
    buffer_load_dwordx4 v[160:163], v17, s[8:11], s37 offen
    s_add_u32 s37, s37, 44032
    buffer_load_dwordx4 v[164:167], v17, s[8:11], s37 offen
    s_add_u32 s37, s37, 44032
    buffer_load_dwordx4 v[168:171], v17, s[8:11], s37 offen
    s_add_u32 s37, s37, 44032
    buffer_load_dwordx4 v[172:175], v17, s[8:11], s37 offen
    buffer_load_dwordx4 v[176:179], v17, s[8:11], s38 offen
    s_add_u32 s38, s38, 44032
    buffer_load_dwordx4 v[180:183], v17, s[8:11], s38 offen
    s_add_u32 s38, s38, 44032
    buffer_load_dwordx4 v[184:187], v17, s[8:11], s38 offen
    s_add_u32 s38, s38, 44032
    buffer_load_dwordx4 v[188:191], v17, s[8:11], s38 offen
    s_add_u32 s35, s35, 1
    s_cmp_ge_u32 s35, s34
    s_cselect_b32 s35, 0, s35
    v_mov_b32 v32, 0
    v_mov_b32 v33, 0
    v_mov_b32 v34, 0
    v_mov_b32 v35, 0
    v_mov_b32 v36, 0
    v_mov_b32 v37, 0
    v_mov_b32 v38, 0
    v_mov_b32 v39, 0
    v_mov_b32 v40, 0
    v_mov_b32 v41, 0
    v_mov_b32 v42, 0
    v_mov_b32 v43, 0
    v_mov_b32 v44, 0
    v_mov_b32 v45, 0
    v_mov_b32 v46, 0
    v_mov_b32 v47, 0
    v_mov_b32 v48, 0
    v_mov_b32 v49, 0
    v_mov_b32 v50, 0
    v_mov_b32 v51, 0
    v_mov_b32 v52, 0
    v_mov_b32 v53, 0
    v_mov_b32 v54, 0
    v_mov_b32 v55, 0
    v_mov_b32 v56, 0
    v_mov_b32 v57, 0
    v_mov_b32 v58, 0
    v_mov_b32 v59, 0
    v_mov_b32 v60, 0
    v_mov_b32 v61, 0
    v_mov_b32 v62, 0
    v_mov_b32 v63, 0
    v_mov_b32 v64, 0
    v_mov_b32 v65, 0
    v_mov_b32 v66, 0
    v_mov_b32 v67, 0
    v_mov_b32 v68, 0
    v_mov_b32 v69, 0
    v_mov_b32 v70, 0
    v_mov_b32 v71, 0
    v_mov_b32 v72, 0
    v_mov_b32 v73, 0
    v_mov_b32 v74, 0
    v_mov_b32 v75, 0
    v_mov_b32 v76, 0
    v_mov_b32 v77, 0
    v_mov_b32 v78, 0
    v_mov_b32 v79, 0
    v_mov_b32 v80, 0
    v_mov_b32 v81, 0
    v_mov_b32 v82, 0
    v_mov_b32 v83, 0
    v_mov_b32 v84, 0
    v_mov_b32 v85, 0
    v_mov_b32 v86, 0
    v_mov_b32 v87, 0
    v_mov_b32 v88, 0
    v_mov_b32 v89, 0
    v_mov_b32 v90, 0
    v_mov_b32 v91, 0
    v_mov_b32 v92, 0
    v_mov_b32 v93, 0
    v_mov_b32 v94, 0
    v_mov_b32 v95, 0
    s_lshl_b32 s36, s35, 2
    s_add_u32 s36, s36, s22
    s_lshl_b32 s36, s36, 10
    s_add_u32 s37, s36, s32
    s_add_u32 s38, s36, s33
    buffer_load_dwordx4 v[192:195], v17, s[8:11], s37 offen
    s_add_u32 s37, s37, 44032
    buffer_load_dwordx4 v[196:199], v17, s[8:11], s37 offen
    s_add_u32 s37, s37, 44032
    buffer_load_dwordx4 v[200:203], v17, s[8:11], s37 offen
    s_add_u32 s37, s37, 44032
    buffer_load_dwordx4 v[204:207], v17, s[8:11], s37 offen
    buffer_load_dwordx4 v[208:211], v17, s[8:11], s38 offen
    s_add_u32 s38, s38, 44032
    buffer_load_dwordx4 v[212:215], v17, s[8:11], s38 offen
    s_add_u32 s38, s38, 44032
    buffer_load_dwordx4 v[216:219], v17, s[8:11], s38 offen
    s_add_u32 s38, s38, 44032
    buffer_load_dwordx4 v[220:223], v17, s[8:11], s38 offen
    s_add_u32 s35, s35, 1
    s_cmp_ge_u32 s35, s34
    s_cselect_b32 s35, 0, s35
    s_waitcnt vmcnt(24)
    v_mfma_f32_16x16x32_bf16 v[32:35], v[96:99], v[112:115], v[32:35]
    v_mfma_f32_16x16x32_bf16 v[36:39], v[100:103], v[112:115], v[36:39]
    v_mfma_f32_16x16x32_bf16 v[40:43], v[104:107], v[112:115], v[40:43]
    v_mfma_f32_16x16x32_bf16 v[44:47], v[108:111], v[112:115], v[44:47]
    v_mfma_f32_16x16x32_bf16 v[48:51], v[96:99], v[116:119], v[48:51]
    v_mfma_f32_16x16x32_bf16 v[52:55], v[100:103], v[116:119], v[52:55]
    v_mfma_f32_16x16x32_bf16 v[56:59], v[104:107], v[116:119], v[56:59]
    v_mfma_f32_16x16x32_bf16 v[60:63], v[108:111], v[116:119], v[60:63]
    v_mfma_f32_16x16x32_bf16 v[64:67], v[96:99], v[120:123], v[64:67]
    v_mfma_f32_16x16x32_bf16 v[68:71], v[100:103], v[120:123], v[68:71]
    v_mfma_f32_16x16x32_bf16 v[72:75], v[104:107], v[120:123], v[72:75]
    v_mfma_f32_16x16x32_bf16 v[76:79], v[108:111], v[120:123], v[76:79]
    v_mfma_f32_16x16x32_bf16 v[80:83], v[96:99], v[124:127], v[80:83]
    v_mfma_f32_16x16x32_bf16 v[84:87], v[100:103], v[124:127], v[84:87]
    v_mfma_f32_16x16x32_bf16 v[88:91], v[104:107], v[124:127], v[88:91]
    v_mfma_f32_16x16x32_bf16 v[92:95], v[108:111], v[124:127], v[92:95]
    s_lshl_b32 s36, s35, 2
    s_add_u32 s36, s36, s22
    s_lshl_b32 s36, s36, 10
    s_add_u32 s37, s36, s32
    s_add_u32 s38, s36, s33
    buffer_load_dwordx4 v[96:99], v17, s[8:11], s37 offen
    s_add_u32 s37, s37, 44032
    buffer_load_dwordx4 v[100:103], v17, s[8:11], s37 offen
    s_add_u32 s37, s37, 44032
    buffer_load_dwordx4 v[104:107], v17, s[8:11], s37 offen
    s_add_u32 s37, s37, 44032
    buffer_load_dwordx4 v[108:111], v17, s[8:11], s37 offen
    buffer_load_dwordx4 v[112:115], v17, s[8:11], s38 offen
    s_add_u32 s38, s38, 44032
    buffer_load_dwordx4 v[116:119], v17, s[8:11], s38 offen
    s_add_u32 s38, s38, 44032
    buffer_load_dwordx4 v[120:123], v17, s[8:11], s38 offen
    s_add_u32 s38, s38, 44032
    buffer_load_dwordx4 v[124:127], v17, s[8:11], s38 offen
    s_add_u32 s35, s35, 1
    s_cmp_ge_u32 s35, s34
    s_cselect_b32 s35, 0, s35
    s_waitcnt vmcnt(24)
    v_mfma_f32_16x16x32_bf16 v[32:35], v[128:131], v[144:147], v[32:35]
    v_mfma_f32_16x16x32_bf16 v[36:39], v[132:135], v[144:147], v[36:39]
    v_mfma_f32_16x16x32_bf16 v[40:43], v[136:139], v[144:147], v[40:43]
    v_mfma_f32_16x16x32_bf16 v[44:47], v[140:143], v[144:147], v[44:47]
    v_mfma_f32_16x16x32_bf16 v[48:51], v[128:131], v[148:151], v[48:51]
    v_mfma_f32_16x16x32_bf16 v[52:55], v[132:135], v[148:151], v[52:55]
    v_mfma_f32_16x16x32_bf16 v[56:59], v[136:139], v[148:151], v[56:59]
    v_mfma_f32_16x16x32_bf16 v[60:63], v[140:143], v[148:151], v[60:63]
    v_mfma_f32_16x16x32_bf16 v[64:67], v[128:131], v[152:155], v[64:67]
    v_mfma_f32_16x16x32_bf16 v[68:71], v[132:135], v[152:155], v[68:71]
    v_mfma_f32_16x16x32_bf16 v[72:75], v[136:139], v[152:155], v[72:75]
    v_mfma_f32_16x16x32_bf16 v[76:79], v[140:143], v[152:155], v[76:79]
    v_mfma_f32_16x16x32_bf16 v[80:83], v[128:131], v[156:159], v[80:83]
    v_mfma_f32_16x16x32_bf16 v[84:87], v[132:135], v[156:159], v[84:87]
    v_mfma_f32_16x16x32_bf16 v[88:91], v[136:139], v[156:159], v[88:91]
    v_mfma_f32_16x16x32_bf16 v[92:95], v[140:143], v[156:159], v[92:95]
    s_lshl_b32 s36, s35, 2
    s_add_u32 s36, s36, s22
    s_lshl_b32 s36, s36, 10
    s_add_u32 s37, s36, s32
    s_add_u32 s38, s36, s33
    buffer_load_dwordx4 v[128:131], v17, s[8:11], s37 offen
    s_add_u32 s37, s37, 44032
    buffer_load_dwordx4 v[132:135], v17, s[8:11], s37 offen
    s_add_u32 s37, s37, 44032
    buffer_load_dwordx4 v[136:139], v17, s[8:11], s37 offen
    s_add_u32 s37, s37, 44032
    buffer_load_dwordx4 v[140:143], v17, s[8:11], s37 offen
    buffer_load_dwordx4 v[144:147], v17, s[8:11], s38 offen
    s_add_u32 s38, s38, 44032
    buffer_load_dwordx4 v[148:151], v17, s[8:11], s38 offen
    s_add_u32 s38, s38, 44032
    buffer_load_dwordx4 v[152:155], v17, s[8:11], s38 offen
    s_add_u32 s38, s38, 44032
    buffer_load_dwordx4 v[156:159], v17, s[8:11], s38 offen
    s_add_u32 s35, s35, 1
    s_cmp_ge_u32 s35, s34
    s_cselect_b32 s35, 0, s35
    s_waitcnt vmcnt(24)
    v_mfma_f32_16x16x32_bf16 v[32:35], v[160:163], v[176:179], v[32:35]
    v_mfma_f32_16x16x32_bf16 v[36:39], v[164:167], v[176:179], v[36:39]
    v_mfma_f32_16x16x32_bf16 v[40:43], v[168:171], v[176:179], v[40:43]
    v_mfma_f32_16x16x32_bf16 v[44:47], v[172:175], v[176:179], v[44:47]
    v_mfma_f32_16x16x32_bf16 v[48:51], v[160:163], v[180:183], v[48:51]
    v_mfma_f32_16x16x32_bf16 v[52:55], v[164:167], v[180:183], v[52:55]
    v_mfma_f32_16x16x32_bf16 v[56:59], v[168:171], v[180:183], v[56:59]
    v_mfma_f32_16x16x32_bf16 v[60:63], v[172:175], v[180:183], v[60:63]
    v_mfma_f32_16x16x32_bf16 v[64:67], v[160:163], v[184:187], v[64:67]
    v_mfma_f32_16x16x32_bf16 v[68:71], v[164:167], v[184:187], v[68:71]
    v_mfma_f32_16x16x32_bf16 v[72:75], v[168:171], v[184:187], v[72:75]
    v_mfma_f32_16x16x32_bf16 v[76:79], v[172:175], v[184:187], v[76:79]
    v_mfma_f32_16x16x32_bf16 v[80:83], v[160:163], v[188:191], v[80:83]
    v_mfma_f32_16x16x32_bf16 v[84:87], v[164:167], v[188:191], v[84:87]
    v_mfma_f32_16x16x32_bf16 v[88:91], v[168:171], v[188:191], v[88:91]
    v_mfma_f32_16x16x32_bf16 v[92:95], v[172:175], v[188:191], v[92:95]
    s_lshl_b32 s36, s35, 2
    s_add_u32 s36, s36, s22
    s_lshl_b32 s36, s36, 10
    s_add_u32 s37, s36, s32
    s_add_u32 s38, s36, s33
    buffer_load_dwordx4 v[160:163], v17, s[8:11], s37 offen
    s_add_u32 s37, s37, 44032
    buffer_load_dwordx4 v[164:167], v17, s[8:11], s37 offen
    s_add_u32 s37, s37, 44032
    buffer_load_dwordx4 v[168:171], v17, s[8:11], s37 offen
    s_add_u32 s37, s37, 44032
    buffer_load_dwordx4 v[172:175], v17, s[8:11], s37 offen
    buffer_load_dwordx4 v[176:179], v17, s[8:11], s38 offen
    s_add_u32 s38, s38, 44032
    buffer_load_dwordx4 v[180:183], v17, s[8:11], s38 offen
    s_add_u32 s38, s38, 44032
    buffer_load_dwordx4 v[184:187], v17, s[8:11], s38 offen
    s_add_u32 s38, s38, 44032
    buffer_load_dwordx4 v[188:191], v17, s[8:11], s38 offen
    s_add_u32 s35, s35, 1
    s_cmp_ge_u32 s35, s34
    s_cselect_b32 s35, 0, s35
    s_waitcnt vmcnt(24)
    v_mfma_f32_16x16x32_bf16 v[32:35], v[192:195], v[208:211], v[32:35]
    v_mfma_f32_16x16x32_bf16 v[36:39], v[196:199], v[208:211], v[36:39]
    v_mfma_f32_16x16x32_bf16 v[40:43], v[200:203], v[208:211], v[40:43]
    v_mfma_f32_16x16x32_bf16 v[44:47], v[204:207], v[208:211], v[44:47]
    v_mfma_f32_16x16x32_bf16 v[48:51], v[192:195], v[212:215], v[48:51]
    v_mfma_f32_16x16x32_bf16 v[52:55], v[196:199], v[212:215], v[52:55]
    v_mfma_f32_16x16x32_bf16 v[56:59], v[200:203], v[212:215], v[56:59]
    v_mfma_f32_16x16x32_bf16 v[60:63], v[204:207], v[212:215], v[60:63]
    v_mfma_f32_16x16x32_bf16 v[64:67], v[192:195], v[216:219], v[64:67]
    v_mfma_f32_16x16x32_bf16 v[68:71], v[196:199], v[216:219], v[68:71]
    v_mfma_f32_16x16x32_bf16 v[72:75], v[200:203], v[216:219], v[72:75]
    v_mfma_f32_16x16x32_bf16 v[76:79], v[204:207], v[216:219], v[76:79]
    v_mfma_f32_16x16x32_bf16 v[80:83], v[192:195], v[220:223], v[80:83]
    v_mfma_f32_16x16x32_bf16 v[84:87], v[196:199], v[220:223], v[84:87]
    v_mfma_f32_16x16x32_bf16 v[88:91], v[200:203], v[220:223], v[88:91]
    v_mfma_f32_16x16x32_bf16 v[92:95], v[204:207], v[220:223], v[92:95]
    s_lshl_b32 s36, s35, 2
    s_add_u32 s36, s36, s22
    s_lshl_b32 s36, s36, 10
    s_add_u32 s37, s36, s32
    s_add_u32 s38, s36, s33
    buffer_load_dwordx4 v[192:195], v17, s[8:11], s37 offen
    s_add_u32 s37, s37, 44032
    buffer_load_dwordx4 v[196:199], v17, s[8:11], s37 offen
    s_add_u32 s37, s37, 44032
    buffer_load_dwordx4 v[200:203], v17, s[8:11], s37 offen
    s_add_u32 s37, s37, 44032
    buffer_load_dwordx4 v[204:207], v17, s[8:11], s37 offen
    buffer_load_dwordx4 v[208:211], v17, s[8:11], s38 offen
    s_add_u32 s38, s38, 44032
    buffer_load_dwordx4 v[212:215], v17, s[8:11], s38 offen
    s_add_u32 s38, s38, 44032
    buffer_load_dwordx4 v[216:219], v17, s[8:11], s38 offen
    s_add_u32 s38, s38, 44032
    buffer_load_dwordx4 v[220:223], v17, s[8:11], s38 offen
    s_add_u32 s35, s35, 1
    s_cmp_ge_u32 s35, s34
    s_cselect_b32 s35, 0, s35
    s_waitcnt vmcnt(24)
    v_mfma_f32_16x16x32_bf16 v[32:35], v[96:99], v[112:115], v[32:35]
    v_mfma_f32_16x16x32_bf16 v[36:39], v[100:103], v[112:115], v[36:39]
    v_mfma_f32_16x16x32_bf16 v[40:43], v[104:107], v[112:115], v[40:43]
    v_mfma_f32_16x16x32_bf16 v[44:47], v[108:111], v[112:115], v[44:47]
    v_mfma_f32_16x16x32_bf16 v[48:51], v[96:99], v[116:119], v[48:51]
    v_mfma_f32_16x16x32_bf16 v[52:55], v[100:103], v[116:119], v[52:55]
    v_mfma_f32_16x16x32_bf16 v[56:59], v[104:107], v[116:119], v[56:59]
    v_mfma_f32_16x16x32_bf16 v[60:63], v[108:111], v[116:119], v[60:63]
    v_mfma_f32_16x16x32_bf16 v[64:67], v[96:99], v[120:123], v[64:67]
    v_mfma_f32_16x16x32_bf16 v[68:71], v[100:103], v[120:123], v[68:71]
    v_mfma_f32_16x16x32_bf16 v[72:75], v[104:107], v[120:123], v[72:75]
    v_mfma_f32_16x16x32_bf16 v[76:79], v[108:111], v[120:123], v[76:79]
    v_mfma_f32_16x16x32_bf16 v[80:83], v[96:99], v[124:127], v[80:83]
    v_mfma_f32_16x16x32_bf16 v[84:87], v[100:103], v[124:127], v[84:87]
    v_mfma_f32_16x16x32_bf16 v[88:91], v[104:107], v[124:127], v[88:91]
    v_mfma_f32_16x16x32_bf16 v[92:95], v[108:111], v[124:127], v[92:95]
    s_lshl_b32 s36, s35, 2
    s_add_u32 s36, s36, s22
    s_lshl_b32 s36, s36, 10
    s_add_u32 s37, s36, s32
    s_add_u32 s38, s36, s33
    buffer_load_dwordx4 v[96:99], v17, s[8:11], s37 offen
    s_add_u32 s37, s37, 44032
    buffer_load_dwordx4 v[100:103], v17, s[8:11], s37 offen
    s_add_u32 s37, s37, 44032
    buffer_load_dwordx4 v[104:107], v17, s[8:11], s37 offen
    s_add_u32 s37, s37, 44032
    buffer_load_dwordx4 v[108:111], v17, s[8:11], s37 offen
    buffer_load_dwordx4 v[112:115], v17, s[8:11], s38 offen
    s_add_u32 s38, s38, 44032
    buffer_load_dwordx4 v[116:119], v17, s[8:11], s38 offen
    s_add_u32 s38, s38, 44032
    buffer_load_dwordx4 v[120:123], v17, s[8:11], s38 offen
    s_add_u32 s38, s38, 44032
    buffer_load_dwordx4 v[124:127], v17, s[8:11], s38 offen
    s_add_u32 s35, s35, 1
    s_cmp_ge_u32 s35, s34
    s_cselect_b32 s35, 0, s35
    s_waitcnt vmcnt(24)
    v_mfma_f32_16x16x32_bf16 v[32:35], v[128:131], v[144:147], v[32:35]
    v_mfma_f32_16x16x32_bf16 v[36:39], v[132:135], v[144:147], v[36:39]
    v_mfma_f32_16x16x32_bf16 v[40:43], v[136:139], v[144:147], v[40:43]
    v_mfma_f32_16x16x32_bf16 v[44:47], v[140:143], v[144:147], v[44:47]
    v_mfma_f32_16x16x32_bf16 v[48:51], v[128:131], v[148:151], v[48:51]
    v_mfma_f32_16x16x32_bf16 v[52:55], v[132:135], v[148:151], v[52:55]
    v_mfma_f32_16x16x32_bf16 v[56:59], v[136:139], v[148:151], v[56:59]
    v_mfma_f32_16x16x32_bf16 v[60:63], v[140:143], v[148:151], v[60:63]
    v_mfma_f32_16x16x32_bf16 v[64:67], v[128:131], v[152:155], v[64:67]
    v_mfma_f32_16x16x32_bf16 v[68:71], v[132:135], v[152:155], v[68:71]
    v_mfma_f32_16x16x32_bf16 v[72:75], v[136:139], v[152:155], v[72:75]
    v_mfma_f32_16x16x32_bf16 v[76:79], v[140:143], v[152:155], v[76:79]
    v_mfma_f32_16x16x32_bf16 v[80:83], v[128:131], v[156:159], v[80:83]
    v_mfma_f32_16x16x32_bf16 v[84:87], v[132:135], v[156:159], v[84:87]
    v_mfma_f32_16x16x32_bf16 v[88:91], v[136:139], v[156:159], v[88:91]
    v_mfma_f32_16x16x32_bf16 v[92:95], v[140:143], v[156:159], v[92:95]
    s_lshl_b32 s36, s35, 2
    s_add_u32 s36, s36, s22
    s_lshl_b32 s36, s36, 10
    s_add_u32 s37, s36, s32
    s_add_u32 s38, s36, s33
    buffer_load_dwordx4 v[128:131], v17, s[8:11], s37 offen
    s_add_u32 s37, s37, 44032
    buffer_load_dwordx4 v[132:135], v17, s[8:11], s37 offen
    s_add_u32 s37, s37, 44032
    buffer_load_dwordx4 v[136:139], v17, s[8:11], s37 offen
    s_add_u32 s37, s37, 44032
    buffer_load_dwordx4 v[140:143], v17, s[8:11], s37 offen
    buffer_load_dwordx4 v[144:147], v17, s[8:11], s38 offen
    s_add_u32 s38, s38, 44032
    buffer_load_dwordx4 v[148:151], v17, s[8:11], s38 offen
    s_add_u32 s38, s38, 44032
    buffer_load_dwordx4 v[152:155], v17, s[8:11], s38 offen
    s_add_u32 s38, s38, 44032
    buffer_load_dwordx4 v[156:159], v17, s[8:11], s38 offen
    s_add_u32 s35, s35, 1
    s_cmp_ge_u32 s35, s34
    s_cselect_b32 s35, 0, s35
    s_waitcnt vmcnt(24)
    v_mfma_f32_16x16x32_bf16 v[32:35], v[160:163], v[176:179], v[32:35]
    v_mfma_f32_16x16x32_bf16 v[36:39], v[164:167], v[176:179], v[36:39]
    v_mfma_f32_16x16x32_bf16 v[40:43], v[168:171], v[176:179], v[40:43]
    v_mfma_f32_16x16x32_bf16 v[44:47], v[172:175], v[176:179], v[44:47]
    v_mfma_f32_16x16x32_bf16 v[48:51], v[160:163], v[180:183], v[48:51]
    v_mfma_f32_16x16x32_bf16 v[52:55], v[164:167], v[180:183], v[52:55]
    v_mfma_f32_16x16x32_bf16 v[56:59], v[168:171], v[180:183], v[56:59]
    v_mfma_f32_16x16x32_bf16 v[60:63], v[172:175], v[180:183], v[60:63]
    v_mfma_f32_16x16x32_bf16 v[64:67], v[160:163], v[184:187], v[64:67]
    v_mfma_f32_16x16x32_bf16 v[68:71], v[164:167], v[184:187], v[68:71]
    v_mfma_f32_16x16x32_bf16 v[72:75], v[168:171], v[184:187], v[72:75]
    v_mfma_f32_16x16x32_bf16 v[76:79], v[172:175], v[184:187], v[76:79]
    v_mfma_f32_16x16x32_bf16 v[80:83], v[160:163], v[188:191], v[80:83]
    v_mfma_f32_16x16x32_bf16 v[84:87], v[164:167], v[188:191], v[84:87]
    v_mfma_f32_16x16x32_bf16 v[88:91], v[168:171], v[188:191], v[88:91]
    v_mfma_f32_16x16x32_bf16 v[92:95], v[172:175], v[188:191], v[92:95]
    s_lshl_b32 s36, s35, 2
    s_add_u32 s36, s36, s22
    s_lshl_b32 s36, s36, 10
    s_add_u32 s37, s36, s32
    s_add_u32 s38, s36, s33
    buffer_load_dwordx4 v[160:163], v17, s[8:11], s37 offen
    s_add_u32 s37, s37, 44032
    buffer_load_dwordx4 v[164:167], v17, s[8:11], s37 offen
    s_add_u32 s37, s37, 44032
    buffer_load_dwordx4 v[168:171], v17, s[8:11], s37 offen
    s_add_u32 s37, s37, 44032
    buffer_load_dwordx4 v[172:175], v17, s[8:11], s37 offen
    buffer_load_dwordx4 v[176:179], v17, s[8:11], s38 offen
    s_add_u32 s38, s38, 44032
    buffer_load_dwordx4 v[180:183], v17, s[8:11], s38 offen
    s_add_u32 s38, s38, 44032
    buffer_load_dwordx4 v[184:187], v17, s[8:11], s38 offen
    s_add_u32 s38, s38, 44032
    buffer_load_dwordx4 v[188:191], v17, s[8:11], s38 offen
    s_add_u32 s35, s35, 1
    s_cmp_ge_u32 s35, s34
    s_cselect_b32 s35, 0, s35
    s_waitcnt vmcnt(24)
    v_mfma_f32_16x16x32_bf16 v[32:35], v[192:195], v[208:211], v[32:35]
    v_mfma_f32_16x16x32_bf16 v[36:39], v[196:199], v[208:211], v[36:39]
    v_mfma_f32_16x16x32_bf16 v[40:43], v[200:203], v[208:211], v[40:43]
    v_mfma_f32_16x16x32_bf16 v[44:47], v[204:207], v[208:211], v[44:47]
    v_mfma_f32_16x16x32_bf16 v[48:51], v[192:195], v[212:215], v[48:51]
    v_mfma_f32_16x16x32_bf16 v[52:55], v[196:199], v[212:215], v[52:55]
    v_mfma_f32_16x16x32_bf16 v[56:59], v[200:203], v[212:215], v[56:59]
    v_mfma_f32_16x16x32_bf16 v[60:63], v[204:207], v[212:215], v[60:63]
    v_mfma_f32_16x16x32_bf16 v[64:67], v[192:195], v[216:219], v[64:67]
    v_mfma_f32_16x16x32_bf16 v[68:71], v[196:199], v[216:219], v[68:71]
    v_mfma_f32_16x16x32_bf16 v[72:75], v[200:203], v[216:219], v[72:75]
    v_mfma_f32_16x16x32_bf16 v[76:79], v[204:207], v[216:219], v[76:79]
    v_mfma_f32_16x16x32_bf16 v[80:83], v[192:195], v[220:223], v[80:83]
    v_mfma_f32_16x16x32_bf16 v[84:87], v[196:199], v[220:223], v[84:87]
    v_mfma_f32_16x16x32_bf16 v[88:91], v[200:203], v[220:223], v[88:91]
    v_mfma_f32_16x16x32_bf16 v[92:95], v[204:207], v[220:223], v[92:95]
    s_waitcnt vmcnt(16)
    v_mfma_f32_16x16x32_bf16 v[32:35], v[96:99], v[112:115], v[32:35]
    v_mfma_f32_16x16x32_bf16 v[36:39], v[100:103], v[112:115], v[36:39]
    v_mfma_f32_16x16x32_bf16 v[40:43], v[104:107], v[112:115], v[40:43]
    v_mfma_f32_16x16x32_bf16 v[44:47], v[108:111], v[112:115], v[44:47]
    v_mfma_f32_16x16x32_bf16 v[48:51], v[96:99], v[116:119], v[48:51]
    v_mfma_f32_16x16x32_bf16 v[52:55], v[100:103], v[116:119], v[52:55]
    v_mfma_f32_16x16x32_bf16 v[56:59], v[104:107], v[116:119], v[56:59]
    v_mfma_f32_16x16x32_bf16 v[60:63], v[108:111], v[116:119], v[60:63]
    v_mfma_f32_16x16x32_bf16 v[64:67], v[96:99], v[120:123], v[64:67]
    v_mfma_f32_16x16x32_bf16 v[68:71], v[100:103], v[120:123], v[68:71]
    v_mfma_f32_16x16x32_bf16 v[72:75], v[104:107], v[120:123], v[72:75]
    v_mfma_f32_16x16x32_bf16 v[76:79], v[108:111], v[120:123], v[76:79]
    v_mfma_f32_16x16x32_bf16 v[80:83], v[96:99], v[124:127], v[80:83]
    v_mfma_f32_16x16x32_bf16 v[84:87], v[100:103], v[124:127], v[84:87]
    v_mfma_f32_16x16x32_bf16 v[88:91], v[104:107], v[124:127], v[88:91]
    v_mfma_f32_16x16x32_bf16 v[92:95], v[108:111], v[124:127], v[92:95]
    s_waitcnt vmcnt(8)
    v_mfma_f32_16x16x32_bf16 v[32:35], v[128:131], v[144:147], v[32:35]
    v_mfma_f32_16x16x32_bf16 v[36:39], v[132:135], v[144:147], v[36:39]
    v_mfma_f32_16x16x32_bf16 v[40:43], v[136:139], v[144:147], v[40:43]
    v_mfma_f32_16x16x32_bf16 v[44:47], v[140:143], v[144:147], v[44:47]
    v_mfma_f32_16x16x32_bf16 v[48:51], v[128:131], v[148:151], v[48:51]
    v_mfma_f32_16x16x32_bf16 v[52:55], v[132:135], v[148:151], v[52:55]
    v_mfma_f32_16x16x32_bf16 v[56:59], v[136:139], v[148:151], v[56:59]
    v_mfma_f32_16x16x32_bf16 v[60:63], v[140:143], v[148:151], v[60:63]
    v_mfma_f32_16x16x32_bf16 v[64:67], v[128:131], v[152:155], v[64:67]
    v_mfma_f32_16x16x32_bf16 v[68:71], v[132:135], v[152:155], v[68:71]
    v_mfma_f32_16x16x32_bf16 v[72:75], v[136:139], v[152:155], v[72:75]
    v_mfma_f32_16x16x32_bf16 v[76:79], v[140:143], v[152:155], v[76:79]
    v_mfma_f32_16x16x32_bf16 v[80:83], v[128:131], v[156:159], v[80:83]
    v_mfma_f32_16x16x32_bf16 v[84:87], v[132:135], v[156:159], v[84:87]
    v_mfma_f32_16x16x32_bf16 v[88:91], v[136:139], v[156:159], v[88:91]
    v_mfma_f32_16x16x32_bf16 v[92:95], v[140:143], v[156:159], v[92:95]
    s_cmp_eq_u32 s22, 3
    s_cbranch_scc1 K5_RED
    s_waitcnt vmcnt(0)
    v_mfma_f32_16x16x32_bf16 v[32:35], v[160:163], v[176:179], v[32:35]
    v_mfma_f32_16x16x32_bf16 v[36:39], v[164:167], v[176:179], v[36:39]
    v_mfma_f32_16x16x32_bf16 v[40:43], v[168:171], v[176:179], v[40:43]
    v_mfma_f32_16x16x32_bf16 v[44:47], v[172:175], v[176:179], v[44:47]
    v_mfma_f32_16x16x32_bf16 v[48:51], v[160:163], v[180:183], v[48:51]
    v_mfma_f32_16x16x32_bf16 v[52:55], v[164:167], v[180:183], v[52:55]
    v_mfma_f32_16x16x32_bf16 v[56:59], v[168:171], v[180:183], v[56:59]
    v_mfma_f32_16x16x32_bf16 v[60:63], v[172:175], v[180:183], v[60:63]
    v_mfma_f32_16x16x32_bf16 v[64:67], v[160:163], v[184:187], v[64:67]
    v_mfma_f32_16x16x32_bf16 v[68:71], v[164:167], v[184:187], v[68:71]
    v_mfma_f32_16x16x32_bf16 v[72:75], v[168:171], v[184:187], v[72:75]
    v_mfma_f32_16x16x32_bf16 v[76:79], v[172:175], v[184:187], v[76:79]
    v_mfma_f32_16x16x32_bf16 v[80:83], v[160:163], v[188:191], v[80:83]
    v_mfma_f32_16x16x32_bf16 v[84:87], v[164:167], v[188:191], v[84:87]
    v_mfma_f32_16x16x32_bf16 v[88:91], v[168:171], v[188:191], v[88:91]
    v_mfma_f32_16x16x32_bf16 v[92:95], v[172:175], v[188:191], v[92:95]
K5_RED:
    s_nop 7
    s_nop 15
    s_nop 7
    s_waitcnt vmcnt(0)
    s_lshl_b32 s23, s22, 14
    v_add_u32 v18, s23, v17
    ds_write_b128 v18, v[32:35] offset:0
    ds_write_b128 v18, v[36:39] offset:1024
    ds_write_b128 v18, v[40:43] offset:2048
    ds_write_b128 v18, v[44:47] offset:3072
    ds_write_b128 v18, v[48:51] offset:4096
    ds_write_b128 v18, v[52:55] offset:5120
    ds_write_b128 v18, v[56:59] offset:6144
    ds_write_b128 v18, v[60:63] offset:7168
    ds_write_b128 v18, v[64:67] offset:8192
    ds_write_b128 v18, v[68:71] offset:9216
    ds_write_b128 v18, v[72:75] offset:10240
    ds_write_b128 v18, v[76:79] offset:11264
    ds_write_b128 v18, v[80:83] offset:12288
    ds_write_b128 v18, v[84:87] offset:13312
    s_waitcnt lgkmcnt(6)
    ds_write_b128 v18, v[88:91] offset:14336
    ds_write_b128 v18, v[92:95] offset:15360
    s_lshl_b32 s23, s22, 4
    s_add_u32 s23, s23, s20
    v_add_u32 v7, s23, v3
    v_lshlrev_b32 v7, 10, v7
    v_lshlrev_b32 v8, 3, v4
    v_add_u32 v8, s21, v8
    v_lshlrev_b32 v8, 1, v8
    v_add_u32 v7, v7, v8
    v_add_u32 v9, 4194304, v7
    buffer_load_dwordx4 v[160:163], v9, s[8:11], 0 offen offset:0
    buffer_load_dwordx4 v[168:171], v8, s[12:15], 0 offen offset:0
    buffer_load_dwordx4 v[164:167], v9, s[8:11], 0 offen offset:64
    buffer_load_dwordx4 v[172:175], v8, s[12:15], 0 offen offset:64
    s_lshl_b32 s23, s22, 12
    v_add_u32 v18, s23, v17
    s_waitcnt lgkmcnt(0)
    s_barrier
    ds_read_b128 v[32:35], v18 offset:0
    ds_read_b128 v[36:39], v18 offset:1024
    ds_read_b128 v[40:43], v18 offset:2048
    ds_read_b128 v[44:47], v18 offset:3072
    ds_read_b128 v[48:51], v18 offset:16384
    ds_read_b128 v[52:55], v18 offset:17408
    ds_read_b128 v[56:59], v18 offset:18432
    ds_read_b128 v[60:63], v18 offset:19456
    ds_read_b128 v[64:67], v18 offset:32768
    ds_read_b128 v[68:71], v18 offset:33792
    ds_read_b128 v[72:75], v18 offset:34816
    ds_read_b128 v[76:79], v18 offset:35840
    ds_read_b128 v[80:83], v18 offset:49152
    ds_read_b128 v[84:87], v18 offset:50176
    s_waitcnt lgkmcnt(6)
    ds_read_b128 v[88:91], v18 offset:51200
    ds_read_b128 v[92:95], v18 offset:52224
    s_waitcnt lgkmcnt(0)
    v_add_f32 v32, v32, v48
    v_add_f32 v64, v64, v80
    v_add_f32 v33, v33, v49
    v_add_f32 v65, v65, v81
    v_add_f32 v34, v34, v50
    v_add_f32 v66, v66, v82
    v_add_f32 v35, v35, v51
    v_add_f32 v67, v67, v83
    v_add_f32 v36, v36, v52
    v_add_f32 v68, v68, v84
    v_add_f32 v37, v37, v53
    v_add_f32 v69, v69, v85
    v_add_f32 v38, v38, v54
    v_add_f32 v70, v70, v86
    v_add_f32 v39, v39, v55
    v_add_f32 v71, v71, v87
    v_add_f32 v40, v40, v56
    v_add_f32 v72, v72, v88
    v_add_f32 v41, v41, v57
    v_add_f32 v73, v73, v89
    v_add_f32 v42, v42, v58
    v_add_f32 v74, v74, v90
    v_add_f32 v43, v43, v59
    v_add_f32 v75, v75, v91
    v_add_f32 v44, v44, v60
    v_add_f32 v76, v76, v92
    v_add_f32 v45, v45, v61
    v_add_f32 v77, v77, v93
    v_add_f32 v46, v46, v62
    v_add_f32 v78, v78, v94
    v_add_f32 v47, v47, v63
    v_add_f32 v79, v79, v95
    v_add_f32 v32, v32, v64
    v_add_f32 v33, v33, v65
    v_add_f32 v34, v34, v66
    v_add_f32 v35, v35, v67
    v_add_f32 v36, v36, v68
    v_add_f32 v37, v37, v69
    v_add_f32 v38, v38, v70
    v_add_f32 v39, v39, v71
    v_add_f32 v40, v40, v72
    v_add_f32 v41, v41, v73
    v_add_f32 v42, v42, v74
    v_add_f32 v43, v43, v75
    v_add_f32 v44, v44, v76
    v_add_f32 v45, v45, v77
    v_add_f32 v46, v46, v78
    v_add_f32 v47, v47, v79
    s_waitcnt vmcnt(0)
    v_cvt_pk_bf16_f32 v120, v32, v33
    v_cvt_pk_bf16_f32 v121, v34, v35
    v_cvt_pk_bf16_f32 v122, v36, v37
    v_cvt_pk_bf16_f32 v123, v38, v39
    v_lshlrev_b32 v96, 16, v120
    v_and_b32 v97, 0xffff0000, v120
    v_lshlrev_b32 v104, 16, v168
    v_and_b32 v105, 0xffff0000, v168
    v_lshlrev_b32 v112, 16, v160
    v_and_b32 v113, 0xffff0000, v160
    v_lshlrev_b32 v98, 16, v121
    v_and_b32 v99, 0xffff0000, v121
    v_lshlrev_b32 v106, 16, v169
    v_and_b32 v107, 0xffff0000, v169
    v_lshlrev_b32 v114, 16, v161
    v_and_b32 v115, 0xffff0000, v161
    v_lshlrev_b32 v100, 16, v122
    v_and_b32 v101, 0xffff0000, v122
    v_lshlrev_b32 v108, 16, v170
    v_and_b32 v109, 0xffff0000, v170
    v_lshlrev_b32 v116, 16, v162
    v_and_b32 v117, 0xffff0000, v162
    v_lshlrev_b32 v102, 16, v123
    v_and_b32 v103, 0xffff0000, v123
    v_lshlrev_b32 v110, 16, v171
    v_and_b32 v111, 0xffff0000, v171
    v_lshlrev_b32 v118, 16, v163
    v_and_b32 v119, 0xffff0000, v163
    v_add_f32 v96, v96, v104
    v_add_f32 v97, v97, v105
    v_add_f32 v98, v98, v106
    v_add_f32 v99, v99, v107
    v_add_f32 v100, v100, v108
    v_add_f32 v101, v101, v109
    v_add_f32 v102, v102, v110
    v_add_f32 v103, v103, v111
    v_cvt_pk_bf16_f32 v120, v96, v97
    v_cvt_pk_bf16_f32 v121, v98, v99
    v_cvt_pk_bf16_f32 v122, v100, v101
    v_cvt_pk_bf16_f32 v123, v102, v103
    v_lshlrev_b32 v96, 16, v120
    v_and_b32 v97, 0xffff0000, v120
    v_lshlrev_b32 v98, 16, v121
    v_and_b32 v99, 0xffff0000, v121
    v_lshlrev_b32 v100, 16, v122
    v_and_b32 v101, 0xffff0000, v122
    v_lshlrev_b32 v102, 16, v123
    v_and_b32 v103, 0xffff0000, v123
    v_add_f32 v96, v96, v112
    v_add_f32 v97, v97, v113
    v_add_f32 v98, v98, v114
    v_add_f32 v99, v99, v115
    v_add_f32 v100, v100, v116
    v_add_f32 v101, v101, v117
    v_add_f32 v102, v102, v118
    v_add_f32 v103, v103, v119
    v_cvt_pk_bf16_f32 v124, v96, v97
    v_cvt_pk_bf16_f32 v125, v98, v99
    v_cvt_pk_bf16_f32 v126, v100, v101
    v_cvt_pk_bf16_f32 v127, v102, v103
    buffer_store_dwordx4 v[124:127], v7, s[28:31], 0 offen offset:0
    v_cvt_pk_bf16_f32 v120, v40, v41
    v_cvt_pk_bf16_f32 v121, v42, v43
    v_cvt_pk_bf16_f32 v122, v44, v45
    v_cvt_pk_bf16_f32 v123, v46, v47
    v_lshlrev_b32 v96, 16, v120
    v_and_b32 v97, 0xffff0000, v120
    v_lshlrev_b32 v104, 16, v172
    v_and_b32 v105, 0xffff0000, v172
    v_lshlrev_b32 v112, 16, v164
    v_and_b32 v113, 0xffff0000, v164
    v_lshlrev_b32 v98, 16, v121
    v_and_b32 v99, 0xffff0000, v121
    v_lshlrev_b32 v106, 16, v173
    v_and_b32 v107, 0xffff0000, v173
    v_lshlrev_b32 v114, 16, v165
    v_and_b32 v115, 0xffff0000, v165
    v_lshlrev_b32 v100, 16, v122
    v_and_b32 v101, 0xffff0000, v122
    v_lshlrev_b32 v108, 16, v174
    v_and_b32 v109, 0xffff0000, v174
    v_lshlrev_b32 v116, 16, v166
    v_and_b32 v117, 0xffff0000, v166
    v_lshlrev_b32 v102, 16, v123
    v_and_b32 v103, 0xffff0000, v123
    v_lshlrev_b32 v110, 16, v175
    v_and_b32 v111, 0xffff0000, v175
    v_lshlrev_b32 v118, 16, v167
    v_and_b32 v119, 0xffff0000, v167
    v_add_f32 v96, v96, v104
    v_add_f32 v97, v97, v105
    v_add_f32 v98, v98, v106
    v_add_f32 v99, v99, v107
    v_add_f32 v100, v100, v108
    v_add_f32 v101, v101, v109
    v_add_f32 v102, v102, v110
    v_add_f32 v103, v103, v111
    v_cvt_pk_bf16_f32 v120, v96, v97
    v_cvt_pk_bf16_f32 v121, v98, v99
    v_cvt_pk_bf16_f32 v122, v100, v101
    v_cvt_pk_bf16_f32 v123, v102, v103
    v_lshlrev_b32 v96, 16, v120
    v_and_b32 v97, 0xffff0000, v120
    v_lshlrev_b32 v98, 16, v121
    v_and_b32 v99, 0xffff0000, v121
    v_lshlrev_b32 v100, 16, v122
    v_and_b32 v101, 0xffff0000, v122
    v_lshlrev_b32 v102, 16, v123
    v_and_b32 v103, 0xffff0000, v123
    v_add_f32 v96, v96, v112
    v_add_f32 v97, v97, v113
    v_add_f32 v98, v98, v114
    v_add_f32 v99, v99, v115
    v_add_f32 v100, v100, v116
    v_add_f32 v101, v101, v117
    v_add_f32 v102, v102, v118
    v_add_f32 v103, v103, v119
    v_cvt_pk_bf16_f32 v128, v96, v97
    v_cvt_pk_bf16_f32 v129, v98, v99
    v_cvt_pk_bf16_f32 v130, v100, v101
    v_cvt_pk_bf16_f32 v131, v102, v103
    buffer_store_dwordx4 v[128:131], v7, s[28:31], 0 offen offset:64
K5_END:
    s_endpgm
.section .rodata,"a"
.p2align 6
.amdhsa_kernel ka_kernel
  .amdhsa_next_free_vgpr 256
  .amdhsa_next_free_sgpr 102
  .amdhsa_accum_offset 256
  .amdhsa_group_segment_fixed_size 0
  .amdhsa_kernarg_size 120
  .amdhsa_user_sgpr_count 2
  .amdhsa_user_sgpr_kernarg_segment_ptr 1
  .amdhsa_system_sgpr_workgroup_id_x 1
  .amdhsa_float_denorm_mode_32 3
.end_amdhsa_kernel
.p2align 6
.amdhsa_kernel k3_kernel
  .amdhsa_next_free_vgpr 64
  .amdhsa_next_free_sgpr 102
  .amdhsa_accum_offset 64
  .amdhsa_group_segment_fixed_size 0
  .amdhsa_kernarg_size 120
  .amdhsa_user_sgpr_count 2
  .amdhsa_user_sgpr_kernarg_segment_ptr 1
  .amdhsa_system_sgpr_workgroup_id_x 1
  .amdhsa_float_denorm_mode_32 3
.end_amdhsa_kernel
.p2align 6
.amdhsa_kernel k4_kernel
  .amdhsa_next_free_vgpr 148
  .amdhsa_next_free_sgpr 102
  .amdhsa_accum_offset 148
  .amdhsa_group_segment_fixed_size 0
  .amdhsa_kernarg_size 120
  .amdhsa_user_sgpr_count 2
  .amdhsa_user_sgpr_kernarg_segment_ptr 1
  .amdhsa_system_sgpr_workgroup_id_x 1
  .amdhsa_float_denorm_mode_32 3
.end_amdhsa_kernel
.p2align 6
.amdhsa_kernel k5_kernel
  .amdhsa_next_free_vgpr 224
  .amdhsa_next_free_sgpr 102
  .amdhsa_accum_offset 224
  .amdhsa_group_segment_fixed_size 0
  .amdhsa_kernarg_size 120
  .amdhsa_user_sgpr_count 2
  .amdhsa_user_sgpr_kernarg_segment_ptr 1
  .amdhsa_system_sgpr_workgroup_id_x 1
  .amdhsa_float_denorm_mode_32 3
.end_amdhsa_kernel
```
